```python
import torch

def _softmax(x, axis=-1):
    return torch.softmax(x, dim=axis)
def _gelu(x):
    return torch.nn.functional.gelu(x, approximate="tanh")
def _silu(x):
    return torch.nn.functional.silu(x)
def _sigmoid(x):
    return torch.sigmoid(x)
def _layernorm(x, axis=-1, eps=1e-5):
    m = x.mean(dim=axis, keepdim=True)
    v = x.var(dim=axis, keepdim=True, unbiased=False)
    return (x - m) / torch.sqrt(v + eps)
def _scatter_add(tgt, idx, src, axis=0):
    return tgt.clone().index_add_(axis, idx, src)
def _segment_sum(src, seg, n):
    out = torch.zeros((n,) + src.shape[1:], dtype=src.dtype)
    return out.index_add_(0, seg, src)
def _pad(x, pw):
    flat = tuple(v for pair in reversed(pw) for v in pair)
    return torch.nn.functional.pad(x, flat)

kernel_name = 'standalone__spectral_fnet__prompt'

def setup_inputs():

    _w = (lambda a: (lambda t: t.to(torch.bfloat16) if t.is_floating_point() else t)(torch.as_tensor(a)))
    B, S, D = 1, 2048, 1024
    ns = torch.arange(S)[:, None] * torch.arange(S)[None, :]
    nd = torch.arange(D)[:, None] * torch.arange(D)[None, :]
    Ws_re = torch.cos(-2.0 * torch.pi * ns / S).to(float)
    Ws_im = torch.sin(-2.0 * torch.pi * ns / S).to(float)
    Wd_re = torch.cos(-2.0 * torch.pi * nd / D).to(float)
    Wd_im = torch.sin(-2.0 * torch.pi * nd / D).to(float)
    return {
        "x": _w((lambda *s: torch.randn(*s, dtype=torch.bfloat16) * 0.05)(B, S, D)),
        "dft_seq_re": _w(Ws_re),
        "dft_seq_im": _w(Ws_im),
        "dft_hid_re": _w(Wd_re),
        "dft_hid_im": _w(Wd_im),
    }

def reference(x, dft_seq_re, dft_seq_im, dft_hid_re, dft_hid_im):
    a = torch.einsum("bsd,ed->bse", x, dft_hid_re)
    b = torch.einsum("bsd,ed->bse", x, dft_hid_im)
    y = torch.einsum("ts,bse->bte", dft_seq_re, a) - torch.einsum("ts,bse->bte", dft_seq_im, b)
    return y
```

```asm
; @launch grid=(256,1,1) block=(512,1,1) lds=163840
.amdgcn_target "amdgcn-amd-amdhsa--gfx950"
.text
    .p2align 8
    .globl standalone__spectral_fnet__prompt_kernel
    .type standalone__spectral_fnet__prompt_kernel,@function
standalone__spectral_fnet__prompt_kernel:
    s_load_dwordx16 s[64:79], s[0:1], 0
    s_cmp_ge_u32 s2, 256
    s_cbranch_scc1 L_exit
    v_lshrrev_b32 v1, 6, v0
    v_and_b32 v0, 63, v0
    v_readfirstlane_b32 s3, v1
    s_and_b32 s12, s2, 7
    s_lshr_b32 s13, s2, 7
    s_lshl_b32 s30, s12, 1
    s_add_u32 s13, s13, s30
    s_bfe_u32 s14, s2, 0x30003
    s_bfe_u32 s15, s2, 0x10006
    s_cmp_lt_u32 s3, 4
    s_cbranch_scc1 L_cons
    s_sub_u32 s3, s3, 4
    v_lshrrev_b32 v1, 4, v0
    v_and_b32 v2, 15, v0
    v_lshlrev_b32 v3, 1, v1
    v_xor_b32 v2, v2, v3
    v_xor_b32 v6, 8, v2
    v_lshlrev_b32 v2, 4, v2
    v_lshl_add_u32 v2, v1, 11, v2
    v_lshlrev_b32 v6, 4, v6
    v_lshl_add_u32 v6, v1, 11, v6
    s_lshl_b32 s30, s3, 15
    s_lshl_b32 s31, s14, 8
    s_add_u32 s30, s30, s31
    s_add_u32 s31, s30, 0
    v_add_u32 v8, s31, v2
    s_add_u32 s31, s30, 7168
    v_add_u32 v9, s31, v2
    s_add_u32 s31, s30, 14336
    v_add_u32 v10, s31, v6
    s_add_u32 s31, s30, 21504
    v_add_u32 v11, s31, v6
    v_lshrrev_b32 v3, 3, v0
    v_and_b32 v4, 7, v0
    v_xor_b32 v4, v4, v1
    v_xor_b32 v5, 4, v4
    v_lshlrev_b32 v4, 4, v4
    v_lshlrev_b32 v5, 4, v5
    v_lshl_add_u32 v2, v3, 12, v4
    v_lshl_add_u32 v6, v3, 12, v5
    s_lshl_b32 s30, s13, 19
    s_lshl_b32 s31, s3, 17
    s_add_u32 s30, s30, s31
    s_add_u32 s31, s30, 0
    v_add_u32 v12, s31, v2
    s_add_u32 s31, s30, 31744
    v_add_u32 v13, s31, v6
    s_add_u32 s31, s30, 63488
    v_add_u32 v14, s31, v2
    s_add_u32 s31, s30, 95232
    v_add_u32 v15, s31, v6
    s_lshl_b32 s42, s3, 12
    s_mov_b32 s33, 0
    s_mov_b32 s34, s14
    s_mul_i32 s30, s15, 4
    s_add_u32 s34, s34, s30
    s_lshr_b32 s33, s2, 7
    s_mul_i32 s33, s33, 4
    s_xor_b32 s35, s33, 7
    s_and_b32 s33, s33, 31
    s_cmp_lt_u32 s33, 8
    s_cselect_b32 s29, s35, 7
    s_add_u32 s30, s33, s34
    s_and_b32 s30, s30, s29
    s_andn2_b32 s31, s33, s29
    s_add_u32 s30, s30, s31
    s_add_u32 s33, s33, 1
    s_lshl_b32 s43, s30, 17
    s_mov_b32 s40, 0
    s_mov_b32 m0, s42
    s_mov_b32 s18, 0x400000
    s_mov_b32 s19, 0x00020000
    s_mov_b32 s22, 0x800000
    s_mov_b32 s23, 0x00020000
    s_cmp_eq_u32 s15, 0
    s_waitcnt lgkmcnt(0)
    s_cselect_b32 s20, s66, s68
    s_cselect_b32 s21, s67, s69
    s_mov_b32 s16, s64
    s_and_b32 s17, s65, 0xffff
    s_and_b32 s21, s21, 0xffff
    buffer_load_dwordx4 v8, s[16:19], s43 offen lds
    s_lshl_b32 s44, s30, 7
    s_add_u32 s45, m0, 16384
    buffer_load_dwordx4 v9, s[16:19], s43 offen offset:1024 lds
    s_add_u32 s40, s40, 32768
    s_cmp_eq_u32 s40, 163840
    buffer_load_dwordx4 v10, s[16:19], s43 offen offset:2048 lds
    s_cselect_b32 s40, 0, s40
    s_add_u32 s46, s40, s42
    buffer_load_dwordx4 v11, s[16:19], s43 offen offset:3072 lds
    s_mov_b32 m0, s45
    s_and_b32 s33, s33, 31
    buffer_load_dwordx4 v12, s[20:23], s44 offen lds
    s_cmp_lt_u32 s33, 8
    s_cselect_b32 s29, s35, 7
    s_add_u32 s30, s33, s34
    buffer_load_dwordx4 v13, s[20:23], s44 offen offset:1024 lds
    s_and_b32 s30, s30, s29
    s_andn2_b32 s31, s33, s29
    s_add_u32 s30, s30, s31
    buffer_load_dwordx4 v14, s[20:23], s44 offen offset:2048 lds
    s_add_u32 s33, s33, 1
    s_lshl_b32 s43, s30, 17
    buffer_load_dwordx4 v15, s[20:23], s44 offen offset:3072 lds
    s_mov_b32 m0, s46
    s_nop 0
    buffer_load_dwordx4 v8, s[16:19], s43 offen lds
    s_lshl_b32 s44, s30, 7
    s_add_u32 s45, m0, 16384
    buffer_load_dwordx4 v9, s[16:19], s43 offen offset:1024 lds
    s_add_u32 s40, s40, 32768
    s_cmp_eq_u32 s40, 163840
    buffer_load_dwordx4 v10, s[16:19], s43 offen offset:2048 lds
    s_cselect_b32 s40, 0, s40
    s_add_u32 s46, s40, s42
    buffer_load_dwordx4 v11, s[16:19], s43 offen offset:3072 lds
    s_mov_b32 m0, s45
    s_and_b32 s33, s33, 31
    buffer_load_dwordx4 v12, s[20:23], s44 offen lds
    s_cmp_lt_u32 s33, 8
    s_cselect_b32 s29, s35, 7
    s_add_u32 s30, s33, s34
    buffer_load_dwordx4 v13, s[20:23], s44 offen offset:1024 lds
    s_and_b32 s30, s30, s29
    s_andn2_b32 s31, s33, s29
    s_add_u32 s30, s30, s31
    buffer_load_dwordx4 v14, s[20:23], s44 offen offset:2048 lds
    s_add_u32 s33, s33, 1
    s_lshl_b32 s43, s30, 17
    buffer_load_dwordx4 v15, s[20:23], s44 offen offset:3072 lds
    s_mov_b32 m0, s46
    s_mov_b32 s24, s78
    s_and_b32 s25, s79, 0xffff
    s_mov_b32 s26, 0x801000
    s_mov_b32 s27, 0x00020000
    s_mov_b32 s52, s70
    s_and_b32 s53, s71, 0xffff
    s_mov_b32 s54, 0x200000
    s_mov_b32 s55, 0x00020000
    s_mov_b32 s60, s76
    s_and_b32 s61, s77, 0xffff
    s_mov_b32 s62, 0x100
    s_mov_b32 s63, 0x00020000
    s_and_b32 s71, s71, 0xffff
    s_and_b32 s73, s73, 0xffff
    s_bfe_u32 s36, s2, 0x40003
    s_lshl_b32 s37, s13, 4
    v_mov_b32 v16, 0
    s_or_b32 s31, s36, s3
    s_cmp_lg_u32 s31, 0
    s_cbranch_scc1 L_nononce
    s_memrealtime s[38:39]
    s_waitcnt lgkmcnt(0)
    s_or_b32 s38, s38, 1
    v_mov_b32 v18, s38
    v_mov_b32 v19, s39
    s_mov_b64 exec, 1
    buffer_store_dwordx2 v[18:19], v16, s[60:63], s37 offen sc1
    s_mov_b64 exec, -1
L_nononce:
    s_waitcnt vmcnt(8)
    s_barrier
    buffer_load_dwordx4 v8, s[16:19], s43 offen lds
    s_lshl_b32 s44, s30, 7
    s_add_u32 s45, m0, 16384
    buffer_load_dwordx4 v9, s[16:19], s43 offen offset:1024 lds
    s_add_u32 s40, s40, 32768
    s_cmp_eq_u32 s40, 163840
    buffer_load_dwordx4 v10, s[16:19], s43 offen offset:2048 lds
    s_cselect_b32 s40, 0, s40
    s_add_u32 s46, s40, s42
    buffer_load_dwordx4 v11, s[16:19], s43 offen offset:3072 lds
    s_mov_b32 m0, s45
    s_and_b32 s33, s33, 31
    buffer_load_dwordx4 v12, s[20:23], s44 offen lds
    s_cmp_lt_u32 s33, 8
    s_cselect_b32 s29, s35, 7
    s_add_u32 s30, s33, s34
    buffer_load_dwordx4 v13, s[20:23], s44 offen offset:1024 lds
    s_and_b32 s30, s30, s29
    s_andn2_b32 s31, s33, s29
    s_add_u32 s30, s30, s31
    buffer_load_dwordx4 v14, s[20:23], s44 offen offset:2048 lds
    s_add_u32 s33, s33, 1
    s_lshl_b32 s43, s30, 17
    buffer_load_dwordx4 v15, s[20:23], s44 offen offset:3072 lds
    s_mov_b32 m0, s46
    s_nop 0
    buffer_load_dwordx4 v8, s[16:19], s43 offen lds
    s_lshl_b32 s44, s30, 7
    s_add_u32 s45, m0, 16384
    buffer_load_dwordx4 v9, s[16:19], s43 offen offset:1024 lds
    s_add_u32 s40, s40, 32768
    s_cmp_eq_u32 s40, 163840
    buffer_load_dwordx4 v10, s[16:19], s43 offen offset:2048 lds
    s_cselect_b32 s40, 0, s40
    s_add_u32 s46, s40, s42
    buffer_load_dwordx4 v11, s[16:19], s43 offen offset:3072 lds
    s_mov_b32 m0, s45
    s_and_b32 s33, s33, 31
    buffer_load_dwordx4 v12, s[20:23], s44 offen lds
    s_cmp_lt_u32 s33, 8
    s_cselect_b32 s29, s35, 7
    s_add_u32 s30, s33, s34
    buffer_load_dwordx4 v13, s[20:23], s44 offen offset:1024 lds
    s_and_b32 s30, s30, s29
    s_andn2_b32 s31, s33, s29
    s_add_u32 s30, s30, s31
    buffer_load_dwordx4 v14, s[20:23], s44 offen offset:2048 lds
    s_add_u32 s33, s33, 1
    s_lshl_b32 s43, s30, 17
    buffer_load_dwordx4 v15, s[20:23], s44 offen offset:3072 lds
    s_mov_b32 m0, s46
    s_waitcnt vmcnt(16)
    s_barrier
    buffer_load_dwordx4 v8, s[16:19], s43 offen lds
    s_lshl_b32 s44, s30, 7
    s_add_u32 s45, m0, 16384
    buffer_load_dwordx4 v9, s[16:19], s43 offen offset:1024 lds
    s_add_u32 s40, s40, 32768
    s_cmp_eq_u32 s40, 163840
    buffer_load_dwordx4 v10, s[16:19], s43 offen offset:2048 lds
    s_cselect_b32 s40, 0, s40
    s_add_u32 s46, s40, s42
    buffer_load_dwordx4 v11, s[16:19], s43 offen offset:3072 lds
    s_mov_b32 m0, s45
    s_and_b32 s33, s33, 31
    buffer_load_dwordx4 v12, s[20:23], s44 offen lds
    s_cmp_lt_u32 s33, 8
    s_cselect_b32 s29, s35, 7
    s_add_u32 s30, s33, s34
    buffer_load_dwordx4 v13, s[20:23], s44 offen offset:1024 lds
    s_and_b32 s30, s30, s29
    s_andn2_b32 s31, s33, s29
    s_add_u32 s30, s30, s31
    buffer_load_dwordx4 v14, s[20:23], s44 offen offset:2048 lds
    s_add_u32 s33, s33, 1
    s_lshl_b32 s43, s30, 17
    buffer_load_dwordx4 v15, s[20:23], s44 offen offset:3072 lds
    s_mov_b32 m0, s46
    s_nop 0
    buffer_load_dwordx4 v8, s[16:19], s43 offen lds
    s_lshl_b32 s44, s30, 7
    s_add_u32 s45, m0, 16384
    buffer_load_dwordx4 v9, s[16:19], s43 offen offset:1024 lds
    s_add_u32 s40, s40, 32768
    s_cmp_eq_u32 s40, 163840
    buffer_load_dwordx4 v10, s[16:19], s43 offen offset:2048 lds
    s_cselect_b32 s40, 0, s40
    s_add_u32 s46, s40, s42
    buffer_load_dwordx4 v11, s[16:19], s43 offen offset:3072 lds
    s_mov_b32 m0, s45
    s_and_b32 s33, s33, 31
    buffer_load_dwordx4 v12, s[20:23], s44 offen lds
    s_cmp_lt_u32 s33, 8
    s_cselect_b32 s29, s35, 7
    s_add_u32 s30, s33, s34
    buffer_load_dwordx4 v13, s[20:23], s44 offen offset:1024 lds
    s_and_b32 s30, s30, s29
    s_andn2_b32 s31, s33, s29
    s_add_u32 s30, s30, s31
    buffer_load_dwordx4 v14, s[20:23], s44 offen offset:2048 lds
    s_add_u32 s33, s33, 1
    s_lshl_b32 s43, s30, 17
    buffer_load_dwordx4 v15, s[20:23], s44 offen offset:3072 lds
    s_mov_b32 m0, s46
    s_waitcnt vmcnt(24)
    s_mov_b32 s41, 26
    s_barrier
L_p1loop:
    buffer_load_dwordx4 v8, s[16:19], s43 offen lds
    s_lshl_b32 s44, s30, 7
    s_add_u32 s45, m0, 16384
    buffer_load_dwordx4 v9, s[16:19], s43 offen offset:1024 lds
    s_add_u32 s40, s40, 32768
    s_cmp_eq_u32 s40, 163840
    buffer_load_dwordx4 v10, s[16:19], s43 offen offset:2048 lds
    s_cselect_b32 s40, 0, s40
    s_add_u32 s46, s40, s42
    buffer_load_dwordx4 v11, s[16:19], s43 offen offset:3072 lds
    s_mov_b32 m0, s45
    s_and_b32 s33, s33, 31
    buffer_load_dwordx4 v12, s[20:23], s44 offen lds
    s_cmp_lt_u32 s33, 8
    s_cselect_b32 s29, s35, 7
    s_add_u32 s30, s33, s34
    s_and_b32 s30, s30, s29
    buffer_load_dwordx4 v13, s[20:23], s44 offen offset:1024 lds
    s_andn2_b32 s31, s33, s29
    s_add_u32 s30, s30, s31
    s_add_u32 s33, s33, 1
    buffer_load_dwordx4 v14, s[20:23], s44 offen offset:2048 lds
    s_lshl_b32 s43, s30, 17
    s_sub_u32 s41, s41, 1
    s_cmp_lg_u32 s41, 0
    buffer_load_dwordx4 v15, s[20:23], s44 offen offset:3072 lds
    s_mov_b32 m0, s46
    s_waitcnt vmcnt(24)
    s_barrier
    s_cbranch_scc1 L_p1loop
    v_lshl_add_u32 v2, v3, 11, v4
    v_lshl_add_u32 v6, v3, 11, v5
    s_lshl_b32 s30, s14, 18
    s_lshl_b32 s31, s3, 16
    s_add_u32 s30, s30, s31
    s_add_u32 s31, s30, 0
    v_add_u32 v8, s31, v2
    s_add_u32 s31, s30, 15360
    v_add_u32 v9, s31, v6
    s_add_u32 s31, s30, 30720
    v_add_u32 v10, s31, v2
    s_add_u32 s31, s30, 46080
    v_add_u32 v11, s31, v6
    s_lshl_b32 s30, s3, 11
    v_lshlrev_b32 v12, 4, v0
    v_add_u32 v12, s30, v12
    s_add_u32 s45, s30, 16384
    s_mul_i32 s38, s12, 4
    s_and_b32 s38, s38, 31
    s_mov_b32 s39, s38
    s_lshl_b32 s34, s13, 1
    s_add_u32 s34, s34, s15
    s_lshl_b32 s34, s34, 18
    s_mov_b32 s33, s40
    s_cmp_lt_u32 s38, 16
    s_cselect_b32 s52, s70, s72
    s_cselect_b32 s53, s71, s73
    s_and_b32 s43, s38, 15
    s_lshl_b32 s43, s43, 7
    s_add_u32 s38, s38, 1
    s_and_b32 s38, s38, 31
    buffer_load_dwordx2 v[18:19], v16, s[60:63], s37 offen sc1
    buffer_load_dwordx4 v8, s[52:55], s43 offen lds
    s_add_u32 s40, s40, 32768
    s_cmp_eq_u32 s40, 163840
    buffer_load_dwordx4 v9, s[52:55], s43 offen offset:1024 lds
    s_cselect_b32 s40, 0, s40
    buffer_load_dwordx4 v10, s[52:55], s43 offen offset:2048 lds
    s_add_u32 s46, s40, s42
    buffer_load_dwordx4 v11, s[52:55], s43 offen offset:3072 lds
    s_mov_b32 m0, s46
    s_cmp_lt_u32 s38, 16
    s_cselect_b32 s52, s70, s72
    s_cselect_b32 s53, s71, s73
    s_and_b32 s43, s38, 15
    s_lshl_b32 s43, s43, 7
    s_add_u32 s38, s38, 1
    s_and_b32 s38, s38, 31
    s_waitcnt vmcnt(21)
    s_barrier
    buffer_load_dwordx4 v8, s[52:55], s43 offen lds
    s_add_u32 s40, s40, 32768
    s_cmp_eq_u32 s40, 163840
    buffer_load_dwordx4 v9, s[52:55], s43 offen offset:1024 lds
    s_cselect_b32 s40, 0, s40
    buffer_load_dwordx4 v10, s[52:55], s43 offen offset:2048 lds
    s_add_u32 s46, s40, s42
    buffer_load_dwordx4 v11, s[52:55], s43 offen offset:3072 lds
    s_mov_b32 m0, s46
    s_cmp_lt_u32 s38, 16
    s_cselect_b32 s52, s70, s72
    s_cselect_b32 s53, s71, s73
    s_and_b32 s43, s38, 15
    s_lshl_b32 s43, s43, 7
    s_add_u32 s38, s38, 1
    s_and_b32 s38, s38, 31
    s_waitcnt vmcnt(17)
    s_barrier
    buffer_load_dwordx4 v8, s[52:55], s43 offen lds
    s_add_u32 s40, s40, 32768
    s_cmp_eq_u32 s40, 163840
    buffer_load_dwordx4 v9, s[52:55], s43 offen offset:1024 lds
    s_cselect_b32 s40, 0, s40
    buffer_load_dwordx4 v10, s[52:55], s43 offen offset:2048 lds
    s_add_u32 s46, s40, s42
    buffer_load_dwordx4 v11, s[52:55], s43 offen offset:3072 lds
    s_mov_b32 m0, s46
    s_cmp_lt_u32 s38, 16
    s_cselect_b32 s52, s70, s72
    s_cselect_b32 s53, s71, s73
    s_and_b32 s43, s38, 15
    s_lshl_b32 s43, s43, 7
    s_add_u32 s38, s38, 1
    s_and_b32 s38, s38, 31
    s_waitcnt vmcnt(12)
    s_barrier
    buffer_load_dwordx4 v8, s[52:55], s43 offen lds
    s_add_u32 s40, s40, 32768
    s_cmp_eq_u32 s40, 163840
    buffer_load_dwordx4 v9, s[52:55], s43 offen offset:1024 lds
    s_cselect_b32 s40, 0, s40
    buffer_load_dwordx4 v10, s[52:55], s43 offen offset:2048 lds
    s_add_u32 s46, s40, s42
    buffer_load_dwordx4 v11, s[52:55], s43 offen offset:3072 lds
    s_mov_b32 m0, s46
    s_cmp_lt_u32 s38, 16
    s_cselect_b32 s52, s70, s72
    s_cselect_b32 s53, s71, s73
    s_and_b32 s43, s38, 15
    s_lshl_b32 s43, s43, 7
    s_add_u32 s38, s38, 1
    s_and_b32 s38, s38, 31
    s_lshl_b32 s30, s13, 8
    s_add_u32 s30, s30, 8388608
    s_lshl_b32 s31, s36, 3
    s_add_u32 s31, s31, s30
    v_and_b32 v17, 15, v0
    v_lshlrev_b32 v17, 3, v17
    s_mov_b32 s35, 0x20000
    s_cmp_lg_u32 s3, 0
    s_cbranch_scc1 L_haveN
L_waitN:
    v_cmp_ne_u32 vcc, 0, v18
    s_sub_u32 s35, s35, 1
    s_cmp_eq_u32 s35, 0
    s_cbranch_scc1 L_haveN
    s_cmp_lg_u64 vcc, 0
    s_cbranch_scc1 L_haveN
    buffer_load_dwordx2 v[18:19], v16, s[60:63], s37 offen sc1
    s_waitcnt vmcnt(0)
    s_branch L_waitN
L_haveN:
    s_barrier
    s_cmp_lg_u32 s3, 0
    s_cbranch_scc1 L_noflag
    s_mov_b64 exec, 1
    buffer_store_dwordx2 v[18:19], v16, s[24:27], s31 offen
    buffer_store_dwordx2 v[18:19], v16, s[24:27], s31 offen offset:128 sc1
    s_mov_b64 exec, -1
L_noflag:
    buffer_load_dwordx4 v8, s[52:55], s43 offen lds
    s_add_u32 s40, s40, 32768
    s_cmp_eq_u32 s40, 163840
    buffer_load_dwordx4 v9, s[52:55], s43 offen offset:1024 lds
    s_cselect_b32 s40, 0, s40
    buffer_load_dwordx4 v10, s[52:55], s43 offen offset:2048 lds
    s_add_u32 s46, s40, s42
    buffer_load_dwordx4 v11, s[52:55], s43 offen offset:3072 lds
    s_mov_b32 m0, s46
    s_cmp_lt_u32 s38, 16
    s_cselect_b32 s52, s70, s72
    s_cselect_b32 s53, s71, s73
    s_and_b32 s43, s38, 15
    s_lshl_b32 s43, s43, 7
    s_add_u32 s38, s38, 1
    s_and_b32 s38, s38, 31
    s_cmp_lg_u32 s3, 0
    s_cbranch_scc1 L_polled
    s_lshl_b32 s30, s13, 8
    s_add_u32 s30, s30, 8388608
    s_mov_b64 s[28:29], 0
L_poll:
    buffer_load_dwordx2 v[20:21], v17, s[24:27], s30 offen sc1
    s_sub_u32 s35, s35, 1
    s_and_b32 s31, s35, 15
    s_waitcnt vmcnt(0)
    v_cmp_eq_u64 vcc, v[18:19], v[20:21]
    s_nop 1
    s_or_b64 vcc, vcc, s[28:29]
    s_cmp_eq_u64 vcc, -1
    s_cbranch_scc1 L_polled
    s_cmp_lg_u32 s31, 0
    s_cbranch_scc1 L_poll
    buffer_load_dwordx2 v[20:21], v17, s[24:27], s30 offen offset:128 sc1
    s_waitcnt vmcnt(0)
    v_cmp_eq_u64 s[28:29], v[18:19], v[20:21]
    s_cmp_gt_u32 s35, 16
    s_cbranch_scc1 L_poll
L_polled:
    s_barrier
    s_lshl_b32 s44, s39, 13
    s_add_u32 s44, s44, s34
    s_add_u32 s39, s39, 1
    s_and_b32 s39, s39, 31
    s_add_u32 m0, s33, s45
    s_add_u32 s33, s33, 32768
    buffer_load_dwordx4 v12, s[24:27], s44 offen sc1 lds
    s_cmp_eq_u32 s33, 163840
    s_cselect_b32 s33, 0, s33
    buffer_load_dwordx4 v12, s[24:27], s44 offen offset:1024 sc1 lds
    s_lshl_b32 s44, s39, 13
    s_add_u32 s44, s44, s34
    s_add_u32 s39, s39, 1
    s_and_b32 s39, s39, 31
    s_add_u32 m0, s33, s45
    s_add_u32 s33, s33, 32768
    buffer_load_dwordx4 v12, s[24:27], s44 offen sc1 lds
    s_cmp_eq_u32 s33, 163840
    s_cselect_b32 s33, 0, s33
    buffer_load_dwordx4 v12, s[24:27], s44 offen offset:1024 sc1 lds
    s_lshl_b32 s44, s39, 13
    s_add_u32 s44, s44, s34
    s_add_u32 s39, s39, 1
    s_and_b32 s39, s39, 31
    s_add_u32 m0, s33, s45
    s_add_u32 s33, s33, 32768
    buffer_load_dwordx4 v12, s[24:27], s44 offen sc1 lds
    s_cmp_eq_u32 s33, 163840
    s_cselect_b32 s33, 0, s33
    buffer_load_dwordx4 v12, s[24:27], s44 offen offset:1024 sc1 lds
    s_lshl_b32 s44, s39, 13
    s_add_u32 s44, s44, s34
    s_add_u32 s39, s39, 1
    s_and_b32 s39, s39, 31
    s_add_u32 m0, s33, s45
    s_add_u32 s33, s33, 32768
    buffer_load_dwordx4 v12, s[24:27], s44 offen sc1 lds
    s_cmp_eq_u32 s33, 163840
    s_cselect_b32 s33, 0, s33
    buffer_load_dwordx4 v12, s[24:27], s44 offen offset:1024 sc1 lds
    s_lshl_b32 s44, s39, 13
    s_add_u32 s44, s44, s34
    s_add_u32 s39, s39, 1
    s_and_b32 s39, s39, 31
    s_add_u32 m0, s33, s45
    s_add_u32 s33, s33, 32768
    buffer_load_dwordx4 v12, s[24:27], s44 offen sc1 lds
    s_cmp_eq_u32 s33, 163840
    s_cselect_b32 s33, 0, s33
    buffer_load_dwordx4 v12, s[24:27], s44 offen offset:1024 sc1 lds
    s_mov_b32 m0, s46
    s_waitcnt vmcnt(8)
    s_barrier
    s_waitcnt vmcnt(6)
    s_barrier
    buffer_load_dwordx4 v8, s[52:55], s43 offen lds
    s_lshl_b32 s44, s39, 13
    s_add_u32 s44, s44, s34
    s_add_u32 s39, s39, 1
    buffer_load_dwordx4 v9, s[52:55], s43 offen offset:1024 lds
    s_and_b32 s39, s39, 31
    s_add_u32 s35, s40, s45
    s_add_u32 s40, s40, 32768
    buffer_load_dwordx4 v10, s[52:55], s43 offen offset:2048 lds
    s_cmp_eq_u32 s40, 163840
    s_cselect_b32 s40, 0, s40
    s_add_u32 s46, s40, s42
    buffer_load_dwordx4 v11, s[52:55], s43 offen offset:3072 lds
    s_mov_b32 m0, s35
    s_cmp_lt_u32 s38, 16
    buffer_load_dwordx4 v12, s[24:27], s44 offen sc1 lds
    s_cselect_b32 s52, s70, s72
    s_cselect_b32 s53, s71, s73
    s_and_b32 s43, s38, 15
    s_lshl_b32 s43, s43, 7
    s_add_u32 s38, s38, 1
    s_and_b32 s38, s38, 31
    buffer_load_dwordx4 v12, s[24:27], s44 offen offset:1024 sc1 lds
    s_mov_b32 m0, s46
    s_waitcnt vmcnt(10)
    s_barrier
    buffer_load_dwordx4 v8, s[52:55], s43 offen lds
    s_lshl_b32 s44, s39, 13
    s_add_u32 s44, s44, s34
    s_add_u32 s39, s39, 1
    buffer_load_dwordx4 v9, s[52:55], s43 offen offset:1024 lds
    s_and_b32 s39, s39, 31
    s_add_u32 s35, s40, s45
    s_add_u32 s40, s40, 32768
    buffer_load_dwordx4 v10, s[52:55], s43 offen offset:2048 lds
    s_cmp_eq_u32 s40, 163840
    s_cselect_b32 s40, 0, s40
    s_add_u32 s46, s40, s42
    buffer_load_dwordx4 v11, s[52:55], s43 offen offset:3072 lds
    s_mov_b32 m0, s35
    s_cmp_lt_u32 s38, 16
    buffer_load_dwordx4 v12, s[24:27], s44 offen sc1 lds
    s_cselect_b32 s52, s70, s72
    s_cselect_b32 s53, s71, s73
    s_and_b32 s43, s38, 15
    s_lshl_b32 s43, s43, 7
    s_add_u32 s38, s38, 1
    s_and_b32 s38, s38, 31
    buffer_load_dwordx4 v12, s[24:27], s44 offen offset:1024 sc1 lds
    s_mov_b32 m0, s46
    s_waitcnt vmcnt(14)
    s_mov_b32 s41, 25
    s_barrier
L_p2loop:
    buffer_load_dwordx4 v8, s[52:55], s43 offen lds
    s_lshl_b32 s44, s39, 13
    s_add_u32 s44, s44, s34
    s_add_u32 s39, s39, 1
    buffer_load_dwordx4 v9, s[52:55], s43 offen offset:1024 lds
    s_and_b32 s39, s39, 31
    s_add_u32 s35, s40, s45
    s_add_u32 s40, s40, 32768
    buffer_load_dwordx4 v10, s[52:55], s43 offen offset:2048 lds
    s_cmp_eq_u32 s40, 163840
    s_cselect_b32 s40, 0, s40
    s_add_u32 s46, s40, s42
    buffer_load_dwordx4 v11, s[52:55], s43 offen offset:3072 lds
    s_mov_b32 m0, s35
    s_cmp_lt_u32 s38, 16
    buffer_load_dwordx4 v12, s[24:27], s44 offen sc1 lds
    s_cselect_b32 s52, s70, s72
    s_cselect_b32 s53, s71, s73
    s_and_b32 s43, s38, 15
    s_lshl_b32 s43, s43, 7
    s_add_u32 s38, s38, 1
    s_and_b32 s38, s38, 31
    s_sub_u32 s41, s41, 1
    s_cmp_lg_u32 s41, 0
    buffer_load_dwordx4 v12, s[24:27], s44 offen offset:1024 sc1 lds
    s_mov_b32 m0, s46
    s_waitcnt vmcnt(18)
    s_barrier
    s_cbranch_scc1 L_p2loop
    s_waitcnt vmcnt(12)
    s_barrier
    s_waitcnt vmcnt(6)
    s_barrier
    s_waitcnt vmcnt(0)
    s_barrier
    s_endpgm
L_cons:
    v_mov_b32 v208, v0
    v_lshlrev_b32 v216, 4, v208
    s_and_b32 s28, s3, 1
    s_lshr_b32 s29, s3, 1
    s_lshl_b32 s30, s2, 2
    s_add_u32 s30, s30, s3
    s_lshl_b32 s33, s30, 12
    s_waitcnt lgkmcnt(0)
    s_mov_b32 s16, s64
    s_and_b32 s17, s65, 0xffff
    s_mov_b32 s18, 0x400000
    s_mov_b32 s19, 0x00020000
    buffer_load_dwordx4 v[220:223], v216, s[16:19], s33 offen offset:0
    buffer_load_dwordx4 v[220:223], v216, s[16:19], s33 offen offset:1024
    buffer_load_dwordx4 v[220:223], v216, s[16:19], s33 offen offset:2048
    buffer_load_dwordx4 v[220:223], v216, s[16:19], s33 offen offset:3072
    s_mov_b32 s24, s78
    s_and_b32 s25, s79, 0xffff
    s_mov_b32 s26, 0x800000
    s_mov_b32 s27, 0x00020000
    s_mov_b32 s56, s74
    s_and_b32 s57, s75, 0xffff
    s_mov_b32 s58, 0x400000
    s_mov_b32 s59, 0x00020000
    v_bfe_u32 v210, v208, 2, 2
    v_and_b32 v212, 3, v208
    v_lshrrev_b32 v209, 4, v208
    v_lshl_add_u32 v211, v209, 3, v210
    v_lshlrev_b32 v211, 8, v211
    v_lshl_add_u32 v211, v212, 3, v211
    v_and_b32 v212, 1, v209
    v_lshl_add_u32 v210, v212, 2, v210
    s_lshl_b32 s30, s28, 2
    s_add_u32 s31, s30, 0
    v_xor_b32 v212, s31, v210
    v_lshl_add_u32 v192, v212, 5, v211
    s_add_u32 s31, s30, 1
    v_xor_b32 v212, s31, v210
    v_lshl_add_u32 v193, v212, 5, v211
    s_add_u32 s31, s30, 2
    v_xor_b32 v212, s31, v210
    v_lshl_add_u32 v194, v212, 5, v211
    s_add_u32 s31, s30, 3
    v_xor_b32 v212, s31, v210
    v_lshl_add_u32 v195, v212, 5, v211
    s_lshl_b32 s30, s29, 13
    s_add_u32 s30, s30, 16384
    v_lshrrev_b32 v209, 4, v208
    v_bfe_u32 v210, v208, 1, 3
    v_xor_b32 v210, v210, v209
    v_and_b32 v209, 15, v208
    v_lshlrev_b32 v209, 7, v209
    v_add_u32 v209, s30, v209
    v_xor_b32 v211, 0, v210
    v_lshl_add_u32 v196, v211, 4, v209
    v_xor_b32 v211, 4, v210
    v_lshl_add_u32 v197, v211, 4, v209
    v_mov_b32 v0, 0
    v_mov_b32 v1, 0
    v_mov_b32 v2, 0
    v_mov_b32 v3, 0
    v_mov_b32 v4, 0
    v_mov_b32 v5, 0
    v_mov_b32 v6, 0
    v_mov_b32 v7, 0
    v_mov_b32 v8, 0
    v_mov_b32 v9, 0
    v_mov_b32 v10, 0
    v_mov_b32 v11, 0
    v_mov_b32 v12, 0
    v_mov_b32 v13, 0
    v_mov_b32 v14, 0
    v_mov_b32 v15, 0
    v_mov_b32 v16, 0
    v_mov_b32 v17, 0
    v_mov_b32 v18, 0
    v_mov_b32 v19, 0
    v_mov_b32 v20, 0
    v_mov_b32 v21, 0
    v_mov_b32 v22, 0
    v_mov_b32 v23, 0
    v_mov_b32 v24, 0
    v_mov_b32 v25, 0
    v_mov_b32 v26, 0
    v_mov_b32 v27, 0
    v_mov_b32 v28, 0
    v_mov_b32 v29, 0
    v_mov_b32 v30, 0
    v_mov_b32 v31, 0
    v_mov_b32 v32, 0
    v_mov_b32 v33, 0
    v_mov_b32 v34, 0
    v_mov_b32 v35, 0
    v_mov_b32 v36, 0
    v_mov_b32 v37, 0
    v_mov_b32 v38, 0
    v_mov_b32 v39, 0
    v_mov_b32 v40, 0
    v_mov_b32 v41, 0
    v_mov_b32 v42, 0
    v_mov_b32 v43, 0
    v_mov_b32 v44, 0
    v_mov_b32 v45, 0
    v_mov_b32 v46, 0
    v_mov_b32 v47, 0
    v_mov_b32 v48, 0
    v_mov_b32 v49, 0
    v_mov_b32 v50, 0
    v_mov_b32 v51, 0
    v_mov_b32 v52, 0
    v_mov_b32 v53, 0
    v_mov_b32 v54, 0
    v_mov_b32 v55, 0
    v_mov_b32 v56, 0
    v_mov_b32 v57, 0
    v_mov_b32 v58, 0
    v_mov_b32 v59, 0
    v_mov_b32 v60, 0
    v_mov_b32 v61, 0
    v_mov_b32 v62, 0
    v_mov_b32 v63, 0
    s_mov_b32 s40, 0
    s_lshl_b32 s30, s13, 1
    s_add_u32 s30, s30, s29
    s_lshl_b32 s30, s30, 5
    s_lshl_b32 s31, s15, 4
    s_add_u32 s30, s30, s31
    s_lshl_b32 s31, s14, 1
    s_add_u32 s30, s30, s31
    s_add_u32 s30, s30, s28
    s_lshl_b32 s44, s30, 13
    s_add_u32 s45, s44, 4096
    s_cmp_eq_u32 s15, 0
    s_cselect_b32 s32, 0, 0x80008000
    v_bfe_u32 v209, v208, 4, 1
    v_lshrrev_b32 v210, 5, v208
    v_lshl_add_u32 v209, v209, 1, v210
    v_bfe_u32 v210, v208, 3, 1
    v_lshl_add_u32 v219, v210, 2, v209
    v_bfe_u32 v210, v208, 1, 2
    v_xor_b32 v210, v210, v219
    v_and_b32 v211, 7, v208
    v_lshlrev_b32 v211, 7, v211
    v_lshl_add_u32 v217, v210, 4, v211
    v_xor_b32 v218, 64, v217
    v_add_u32 v218, 1024, v218
    v_add_u32 v200, s40, v192
    v_add_u32 v201, s40, v193
    v_add_u32 v202, s40, v194
    v_add_u32 v203, s40, v195
    v_add_u32 v204, s40, v196
    v_add_u32 v205, s40, v197
    s_add_u32 s40, s40, 32768
    s_cmp_eq_u32 s40, 163840
    s_cselect_b32 s40, 0, s40
    s_barrier
    ds_read_b64_tr_b16 v[64:65], v200 offset:0
    ds_read_b64_tr_b16 v[66:67], v200 offset:1024
    ds_read_b64_tr_b16 v[68:69], v201 offset:0
    ds_read_b64_tr_b16 v[70:71], v201 offset:1024
    ds_read_b64_tr_b16 v[72:73], v202 offset:0
    ds_read_b64_tr_b16 v[74:75], v202 offset:1024
    ds_read_b64_tr_b16 v[76:77], v203 offset:0
    ds_read_b64_tr_b16 v[78:79], v203 offset:1024
    ds_read_b128 v[80:83], v204 offset:0
    ds_read_b128 v[84:87], v204 offset:2048
    ds_read_b128 v[88:91], v204 offset:4096
    ds_read_b128 v[92:95], v204 offset:6144
    ds_read_b64_tr_b16 v[96:97], v200 offset:8192
    ds_read_b64_tr_b16 v[98:99], v200 offset:9216
    ds_read_b64_tr_b16 v[100:101], v201 offset:8192
    ds_read_b64_tr_b16 v[102:103], v201 offset:9216
    ds_read_b64_tr_b16 v[104:105], v202 offset:8192
    ds_read_b64_tr_b16 v[106:107], v202 offset:9216
    ds_read_b64_tr_b16 v[108:109], v203 offset:8192
    ds_read_b64_tr_b16 v[110:111], v203 offset:9216
    ds_read_b128 v[112:115], v205 offset:0
    ds_read_b128 v[116:119], v205 offset:2048
    ds_read_b128 v[120:123], v205 offset:4096
    ds_read_b128 v[124:127], v205 offset:6144
    v_add_u32 v200, s40, v192
    v_add_u32 v201, s40, v193
    v_add_u32 v202, s40, v194
    v_add_u32 v203, s40, v195
    v_add_u32 v204, s40, v196
    v_add_u32 v205, s40, v197
    s_add_u32 s40, s40, 32768
    s_cmp_eq_u32 s40, 163840
    s_cselect_b32 s40, 0, s40
    s_mov_b32 s41, 14
    s_waitcnt lgkmcnt(0)
    s_barrier
    v_mfma_f32_16x16x32_bf16 v[0:3], v[64:67], v[80:83], v[0:3]
    ds_read_b64_tr_b16 v[128:129], v200 offset:0
    ds_read_b64_tr_b16 v[130:131], v200 offset:1024
    v_mfma_f32_16x16x32_bf16 v[16:19], v[68:71], v[80:83], v[16:19]
    ds_read_b64_tr_b16 v[132:133], v201 offset:0
    v_mfma_f32_16x16x32_bf16 v[32:35], v[72:75], v[80:83], v[32:35]
    ds_read_b64_tr_b16 v[134:135], v201 offset:1024
    ds_read_b64_tr_b16 v[136:137], v202 offset:0
    v_mfma_f32_16x16x32_bf16 v[48:51], v[76:79], v[80:83], v[48:51]
    ds_read_b64_tr_b16 v[138:139], v202 offset:1024
    v_mfma_f32_16x16x32_bf16 v[4:7], v[64:67], v[84:87], v[4:7]
    ds_read_b64_tr_b16 v[140:141], v203 offset:0
    ds_read_b64_tr_b16 v[142:143], v203 offset:1024
    v_mfma_f32_16x16x32_bf16 v[20:23], v[68:71], v[84:87], v[20:23]
    ds_read_b128 v[144:147], v204 offset:0
    v_mfma_f32_16x16x32_bf16 v[36:39], v[72:75], v[84:87], v[36:39]
    ds_read_b128 v[148:151], v204 offset:2048
    ds_read_b128 v[152:155], v204 offset:4096
    v_mfma_f32_16x16x32_bf16 v[52:55], v[76:79], v[84:87], v[52:55]
    ds_read_b128 v[156:159], v204 offset:6144
    v_mfma_f32_16x16x32_bf16 v[8:11], v[64:67], v[88:91], v[8:11]
    ds_read_b64_tr_b16 v[160:161], v200 offset:8192
    ds_read_b64_tr_b16 v[162:163], v200 offset:9216
    v_mfma_f32_16x16x32_bf16 v[24:27], v[68:71], v[88:91], v[24:27]
    ds_read_b64_tr_b16 v[164:165], v201 offset:8192
    v_mfma_f32_16x16x32_bf16 v[40:43], v[72:75], v[88:91], v[40:43]
    ds_read_b64_tr_b16 v[166:167], v201 offset:9216
    ds_read_b64_tr_b16 v[168:169], v202 offset:8192
    v_mfma_f32_16x16x32_bf16 v[56:59], v[76:79], v[88:91], v[56:59]
    ds_read_b64_tr_b16 v[170:171], v202 offset:9216
    v_mfma_f32_16x16x32_bf16 v[12:15], v[64:67], v[92:95], v[12:15]
    ds_read_b64_tr_b16 v[172:173], v203 offset:8192
    ds_read_b64_tr_b16 v[174:175], v203 offset:9216
    v_mfma_f32_16x16x32_bf16 v[28:31], v[68:71], v[92:95], v[28:31]
    ds_read_b128 v[176:179], v205 offset:0
    v_mfma_f32_16x16x32_bf16 v[44:47], v[72:75], v[92:95], v[44:47]
    ds_read_b128 v[180:183], v205 offset:2048
    ds_read_b128 v[184:187], v205 offset:4096
    v_mfma_f32_16x16x32_bf16 v[60:63], v[76:79], v[92:95], v[60:63]
    ds_read_b128 v[188:191], v205 offset:6144
    v_mfma_f32_16x16x32_bf16 v[0:3], v[96:99], v[112:115], v[0:3]
    v_add_u32 v200, s40, v192
    v_add_u32 v201, s40, v193
    v_mfma_f32_16x16x32_bf16 v[16:19], v[100:103], v[112:115], v[16:19]
    v_add_u32 v202, s40, v194
    v_mfma_f32_16x16x32_bf16 v[32:35], v[104:107], v[112:115], v[32:35]
    v_add_u32 v203, s40, v195
    v_mfma_f32_16x16x32_bf16 v[48:51], v[108:111], v[112:115], v[48:51]
    v_add_u32 v204, s40, v196
    v_add_u32 v205, s40, v197
    v_mfma_f32_16x16x32_bf16 v[4:7], v[96:99], v[116:119], v[4:7]
    s_add_u32 s40, s40, 32768
    v_mfma_f32_16x16x32_bf16 v[20:23], v[100:103], v[116:119], v[20:23]
    s_cmp_eq_u32 s40, 163840
    v_mfma_f32_16x16x32_bf16 v[36:39], v[104:107], v[116:119], v[36:39]
    s_cselect_b32 s40, 0, s40
    v_mfma_f32_16x16x32_bf16 v[52:55], v[108:111], v[116:119], v[52:55]
L_s1_cloop:
    s_waitcnt lgkmcnt(0)
    s_barrier
    v_mfma_f32_16x16x32_bf16 v[8:11], v[96:99], v[120:123], v[8:11]
    ds_read_b64_tr_b16 v[64:65], v200 offset:0
    v_mfma_f32_16x16x32_bf16 v[24:27], v[100:103], v[120:123], v[24:27]
    ds_read_b64_tr_b16 v[66:67], v200 offset:1024
    v_mfma_f32_16x16x32_bf16 v[40:43], v[104:107], v[120:123], v[40:43]
    ds_read_b64_tr_b16 v[68:69], v201 offset:0
    v_mfma_f32_16x16x32_bf16 v[56:59], v[108:111], v[120:123], v[56:59]
    ds_read_b64_tr_b16 v[70:71], v201 offset:1024
    v_mfma_f32_16x16x32_bf16 v[12:15], v[96:99], v[124:127], v[12:15]
    ds_read_b64_tr_b16 v[72:73], v202 offset:0
    v_mfma_f32_16x16x32_bf16 v[28:31], v[100:103], v[124:127], v[28:31]
    ds_read_b64_tr_b16 v[74:75], v202 offset:1024
    v_mfma_f32_16x16x32_bf16 v[44:47], v[104:107], v[124:127], v[44:47]
    ds_read_b64_tr_b16 v[76:77], v203 offset:0
    v_mfma_f32_16x16x32_bf16 v[60:63], v[108:111], v[124:127], v[60:63]
    ds_read_b64_tr_b16 v[78:79], v203 offset:1024
    v_mfma_f32_16x16x32_bf16 v[0:3], v[128:131], v[144:147], v[0:3]
    ds_read_b128 v[80:83], v204 offset:0
    v_mfma_f32_16x16x32_bf16 v[16:19], v[132:135], v[144:147], v[16:19]
    ds_read_b128 v[84:87], v204 offset:2048
    v_mfma_f32_16x16x32_bf16 v[32:35], v[136:139], v[144:147], v[32:35]
    ds_read_b128 v[88:91], v204 offset:4096
    v_mfma_f32_16x16x32_bf16 v[48:51], v[140:143], v[144:147], v[48:51]
    ds_read_b128 v[92:95], v204 offset:6144
    v_mfma_f32_16x16x32_bf16 v[4:7], v[128:131], v[148:151], v[4:7]
    ds_read_b64_tr_b16 v[96:97], v200 offset:8192
    v_mfma_f32_16x16x32_bf16 v[20:23], v[132:135], v[148:151], v[20:23]
    ds_read_b64_tr_b16 v[98:99], v200 offset:9216
    v_mfma_f32_16x16x32_bf16 v[36:39], v[136:139], v[148:151], v[36:39]
    ds_read_b64_tr_b16 v[100:101], v201 offset:8192
    v_mfma_f32_16x16x32_bf16 v[52:55], v[140:143], v[148:151], v[52:55]
    ds_read_b64_tr_b16 v[102:103], v201 offset:9216
    v_mfma_f32_16x16x32_bf16 v[8:11], v[128:131], v[152:155], v[8:11]
    ds_read_b64_tr_b16 v[104:105], v202 offset:8192
    v_mfma_f32_16x16x32_bf16 v[24:27], v[132:135], v[152:155], v[24:27]
    ds_read_b64_tr_b16 v[106:107], v202 offset:9216
    v_mfma_f32_16x16x32_bf16 v[40:43], v[136:139], v[152:155], v[40:43]
    ds_read_b64_tr_b16 v[108:109], v203 offset:8192
    v_mfma_f32_16x16x32_bf16 v[56:59], v[140:143], v[152:155], v[56:59]
    ds_read_b64_tr_b16 v[110:111], v203 offset:9216
    v_mfma_f32_16x16x32_bf16 v[12:15], v[128:131], v[156:159], v[12:15]
    ds_read_b128 v[112:115], v205 offset:0
    v_mfma_f32_16x16x32_bf16 v[28:31], v[132:135], v[156:159], v[28:31]
    ds_read_b128 v[116:119], v205 offset:2048
    v_mfma_f32_16x16x32_bf16 v[44:47], v[136:139], v[156:159], v[44:47]
    ds_read_b128 v[120:123], v205 offset:4096
    v_mfma_f32_16x16x32_bf16 v[60:63], v[140:143], v[156:159], v[60:63]
    ds_read_b128 v[124:127], v205 offset:6144
    v_mfma_f32_16x16x32_bf16 v[0:3], v[160:163], v[176:179], v[0:3]
    v_add_u32 v200, s40, v192
    v_add_u32 v201, s40, v193
    v_mfma_f32_16x16x32_bf16 v[16:19], v[164:167], v[176:179], v[16:19]
    v_add_u32 v202, s40, v194
    v_mfma_f32_16x16x32_bf16 v[32:35], v[168:171], v[176:179], v[32:35]
    v_add_u32 v203, s40, v195
    v_mfma_f32_16x16x32_bf16 v[48:51], v[172:175], v[176:179], v[48:51]
    v_add_u32 v204, s40, v196
    v_add_u32 v205, s40, v197
    v_mfma_f32_16x16x32_bf16 v[4:7], v[160:163], v[180:183], v[4:7]
    s_add_u32 s40, s40, 32768
    v_mfma_f32_16x16x32_bf16 v[20:23], v[164:167], v[180:183], v[20:23]
    s_cmp_eq_u32 s40, 163840
    v_mfma_f32_16x16x32_bf16 v[36:39], v[168:171], v[180:183], v[36:39]
    s_cselect_b32 s40, 0, s40
    v_mfma_f32_16x16x32_bf16 v[52:55], v[172:175], v[180:183], v[52:55]
    s_waitcnt lgkmcnt(0)
    s_barrier
    v_mfma_f32_16x16x32_bf16 v[8:11], v[160:163], v[184:187], v[8:11]
    ds_read_b64_tr_b16 v[128:129], v200 offset:0
    v_mfma_f32_16x16x32_bf16 v[24:27], v[164:167], v[184:187], v[24:27]
    ds_read_b64_tr_b16 v[130:131], v200 offset:1024
    v_mfma_f32_16x16x32_bf16 v[40:43], v[168:171], v[184:187], v[40:43]
    ds_read_b64_tr_b16 v[132:133], v201 offset:0
    v_mfma_f32_16x16x32_bf16 v[56:59], v[172:175], v[184:187], v[56:59]
    ds_read_b64_tr_b16 v[134:135], v201 offset:1024
    v_mfma_f32_16x16x32_bf16 v[12:15], v[160:163], v[188:191], v[12:15]
    ds_read_b64_tr_b16 v[136:137], v202 offset:0
    v_mfma_f32_16x16x32_bf16 v[28:31], v[164:167], v[188:191], v[28:31]
    ds_read_b64_tr_b16 v[138:139], v202 offset:1024
    v_mfma_f32_16x16x32_bf16 v[44:47], v[168:171], v[188:191], v[44:47]
    ds_read_b64_tr_b16 v[140:141], v203 offset:0
    v_mfma_f32_16x16x32_bf16 v[60:63], v[172:175], v[188:191], v[60:63]
    ds_read_b64_tr_b16 v[142:143], v203 offset:1024
    v_mfma_f32_16x16x32_bf16 v[0:3], v[64:67], v[80:83], v[0:3]
    ds_read_b128 v[144:147], v204 offset:0
    v_mfma_f32_16x16x32_bf16 v[16:19], v[68:71], v[80:83], v[16:19]
    ds_read_b128 v[148:151], v204 offset:2048
    v_mfma_f32_16x16x32_bf16 v[32:35], v[72:75], v[80:83], v[32:35]
    ds_read_b128 v[152:155], v204 offset:4096
    v_mfma_f32_16x16x32_bf16 v[48:51], v[76:79], v[80:83], v[48:51]
    ds_read_b128 v[156:159], v204 offset:6144
    v_mfma_f32_16x16x32_bf16 v[4:7], v[64:67], v[84:87], v[4:7]
    ds_read_b64_tr_b16 v[160:161], v200 offset:8192
    v_mfma_f32_16x16x32_bf16 v[20:23], v[68:71], v[84:87], v[20:23]
    ds_read_b64_tr_b16 v[162:163], v200 offset:9216
    v_mfma_f32_16x16x32_bf16 v[36:39], v[72:75], v[84:87], v[36:39]
    ds_read_b64_tr_b16 v[164:165], v201 offset:8192
    v_mfma_f32_16x16x32_bf16 v[52:55], v[76:79], v[84:87], v[52:55]
    ds_read_b64_tr_b16 v[166:167], v201 offset:9216
    v_mfma_f32_16x16x32_bf16 v[8:11], v[64:67], v[88:91], v[8:11]
    ds_read_b64_tr_b16 v[168:169], v202 offset:8192
    v_mfma_f32_16x16x32_bf16 v[24:27], v[68:71], v[88:91], v[24:27]
    ds_read_b64_tr_b16 v[170:171], v202 offset:9216
    v_mfma_f32_16x16x32_bf16 v[40:43], v[72:75], v[88:91], v[40:43]
    ds_read_b64_tr_b16 v[172:173], v203 offset:8192
    v_mfma_f32_16x16x32_bf16 v[56:59], v[76:79], v[88:91], v[56:59]
    ds_read_b64_tr_b16 v[174:175], v203 offset:9216
    v_mfma_f32_16x16x32_bf16 v[12:15], v[64:67], v[92:95], v[12:15]
    ds_read_b128 v[176:179], v205 offset:0
    v_mfma_f32_16x16x32_bf16 v[28:31], v[68:71], v[92:95], v[28:31]
    ds_read_b128 v[180:183], v205 offset:2048
    v_mfma_f32_16x16x32_bf16 v[44:47], v[72:75], v[92:95], v[44:47]
    ds_read_b128 v[184:187], v205 offset:4096
    v_mfma_f32_16x16x32_bf16 v[60:63], v[76:79], v[92:95], v[60:63]
    ds_read_b128 v[188:191], v205 offset:6144
    v_mfma_f32_16x16x32_bf16 v[0:3], v[96:99], v[112:115], v[0:3]
    v_add_u32 v200, s40, v192
    v_add_u32 v201, s40, v193
    v_mfma_f32_16x16x32_bf16 v[16:19], v[100:103], v[112:115], v[16:19]
    v_add_u32 v202, s40, v194
    v_add_u32 v203, s40, v195
    v_mfma_f32_16x16x32_bf16 v[32:35], v[104:107], v[112:115], v[32:35]
    v_add_u32 v204, s40, v196
    v_mfma_f32_16x16x32_bf16 v[48:51], v[108:111], v[112:115], v[48:51]
    v_add_u32 v205, s40, v197
    s_add_u32 s40, s40, 32768
    v_mfma_f32_16x16x32_bf16 v[4:7], v[96:99], v[116:119], v[4:7]
    s_cmp_eq_u32 s40, 163840
    v_mfma_f32_16x16x32_bf16 v[20:23], v[100:103], v[116:119], v[20:23]
    s_cselect_b32 s40, 0, s40
    s_sub_u32 s41, s41, 1
    v_mfma_f32_16x16x32_bf16 v[36:39], v[104:107], v[116:119], v[36:39]
    s_cmp_lg_u32 s41, 0
    v_mfma_f32_16x16x32_bf16 v[52:55], v[108:111], v[116:119], v[52:55]
    s_cbranch_scc1 L_s1_cloop
    s_waitcnt lgkmcnt(0)
    s_barrier
    v_mfma_f32_16x16x32_bf16 v[8:11], v[96:99], v[120:123], v[8:11]
    ds_read_b64_tr_b16 v[64:65], v200 offset:0
    v_mfma_f32_16x16x32_bf16 v[24:27], v[100:103], v[120:123], v[24:27]
    ds_read_b64_tr_b16 v[66:67], v200 offset:1024
    v_mfma_f32_16x16x32_bf16 v[40:43], v[104:107], v[120:123], v[40:43]
    ds_read_b64_tr_b16 v[68:69], v201 offset:0
    v_mfma_f32_16x16x32_bf16 v[56:59], v[108:111], v[120:123], v[56:59]
    ds_read_b64_tr_b16 v[70:71], v201 offset:1024
    v_mfma_f32_16x16x32_bf16 v[12:15], v[96:99], v[124:127], v[12:15]
    ds_read_b64_tr_b16 v[72:73], v202 offset:0
    v_mfma_f32_16x16x32_bf16 v[28:31], v[100:103], v[124:127], v[28:31]
    ds_read_b64_tr_b16 v[74:75], v202 offset:1024
    v_mfma_f32_16x16x32_bf16 v[44:47], v[104:107], v[124:127], v[44:47]
    ds_read_b64_tr_b16 v[76:77], v203 offset:0
    v_mfma_f32_16x16x32_bf16 v[60:63], v[108:111], v[124:127], v[60:63]
    ds_read_b64_tr_b16 v[78:79], v203 offset:1024
    v_mfma_f32_16x16x32_bf16 v[0:3], v[128:131], v[144:147], v[0:3]
    ds_read_b128 v[80:83], v204 offset:0
    v_mfma_f32_16x16x32_bf16 v[16:19], v[132:135], v[144:147], v[16:19]
    ds_read_b128 v[84:87], v204 offset:2048
    v_mfma_f32_16x16x32_bf16 v[32:35], v[136:139], v[144:147], v[32:35]
    ds_read_b128 v[88:91], v204 offset:4096
    v_mfma_f32_16x16x32_bf16 v[48:51], v[140:143], v[144:147], v[48:51]
    ds_read_b128 v[92:95], v204 offset:6144
    v_mfma_f32_16x16x32_bf16 v[4:7], v[128:131], v[148:151], v[4:7]
    ds_read_b64_tr_b16 v[96:97], v200 offset:8192
    v_mfma_f32_16x16x32_bf16 v[20:23], v[132:135], v[148:151], v[20:23]
    ds_read_b64_tr_b16 v[98:99], v200 offset:9216
    v_mfma_f32_16x16x32_bf16 v[36:39], v[136:139], v[148:151], v[36:39]
    ds_read_b64_tr_b16 v[100:101], v201 offset:8192
    v_mfma_f32_16x16x32_bf16 v[52:55], v[140:143], v[148:151], v[52:55]
    ds_read_b64_tr_b16 v[102:103], v201 offset:9216
    v_mfma_f32_16x16x32_bf16 v[8:11], v[128:131], v[152:155], v[8:11]
    ds_read_b64_tr_b16 v[104:105], v202 offset:8192
    v_mfma_f32_16x16x32_bf16 v[24:27], v[132:135], v[152:155], v[24:27]
    ds_read_b64_tr_b16 v[106:107], v202 offset:9216
    v_mfma_f32_16x16x32_bf16 v[40:43], v[136:139], v[152:155], v[40:43]
    ds_read_b64_tr_b16 v[108:109], v203 offset:8192
    v_mfma_f32_16x16x32_bf16 v[56:59], v[140:143], v[152:155], v[56:59]
    ds_read_b64_tr_b16 v[110:111], v203 offset:9216
    v_mfma_f32_16x16x32_bf16 v[12:15], v[128:131], v[156:159], v[12:15]
    ds_read_b128 v[112:115], v205 offset:0
    v_mfma_f32_16x16x32_bf16 v[28:31], v[132:135], v[156:159], v[28:31]
    ds_read_b128 v[116:119], v205 offset:2048
    v_mfma_f32_16x16x32_bf16 v[44:47], v[136:139], v[156:159], v[44:47]
    ds_read_b128 v[120:123], v205 offset:4096
    v_mfma_f32_16x16x32_bf16 v[60:63], v[140:143], v[156:159], v[60:63]
    ds_read_b128 v[124:127], v205 offset:6144
    v_mfma_f32_16x16x32_bf16 v[0:3], v[160:163], v[176:179], v[0:3]
    v_add_u32 v200, s40, v192
    v_add_u32 v201, s40, v193
    v_mfma_f32_16x16x32_bf16 v[16:19], v[164:167], v[176:179], v[16:19]
    v_add_u32 v202, s40, v194
    v_mfma_f32_16x16x32_bf16 v[32:35], v[168:171], v[176:179], v[32:35]
    v_add_u32 v203, s40, v195
    v_mfma_f32_16x16x32_bf16 v[48:51], v[172:175], v[176:179], v[48:51]
    v_add_u32 v204, s40, v196
    v_add_u32 v205, s40, v197
    v_mfma_f32_16x16x32_bf16 v[4:7], v[160:163], v[180:183], v[4:7]
    s_add_u32 s40, s40, 32768
    v_mfma_f32_16x16x32_bf16 v[20:23], v[164:167], v[180:183], v[20:23]
    s_cmp_eq_u32 s40, 163840
    v_mfma_f32_16x16x32_bf16 v[36:39], v[168:171], v[180:183], v[36:39]
    s_cselect_b32 s40, 0, s40
    v_mfma_f32_16x16x32_bf16 v[52:55], v[172:175], v[180:183], v[52:55]
    s_waitcnt lgkmcnt(0)
    s_barrier
    v_mfma_f32_16x16x32_bf16 v[8:11], v[160:163], v[184:187], v[8:11]
    ds_read_b64_tr_b16 v[128:129], v200 offset:0
    v_mfma_f32_16x16x32_bf16 v[24:27], v[164:167], v[184:187], v[24:27]
    ds_read_b64_tr_b16 v[130:131], v200 offset:1024
    v_mfma_f32_16x16x32_bf16 v[40:43], v[168:171], v[184:187], v[40:43]
    ds_read_b64_tr_b16 v[132:133], v201 offset:0
    v_mfma_f32_16x16x32_bf16 v[56:59], v[172:175], v[184:187], v[56:59]
    ds_read_b64_tr_b16 v[134:135], v201 offset:1024
    v_mfma_f32_16x16x32_bf16 v[12:15], v[160:163], v[188:191], v[12:15]
    ds_read_b64_tr_b16 v[136:137], v202 offset:0
    v_mfma_f32_16x16x32_bf16 v[28:31], v[164:167], v[188:191], v[28:31]
    ds_read_b64_tr_b16 v[138:139], v202 offset:1024
    v_mfma_f32_16x16x32_bf16 v[44:47], v[168:171], v[188:191], v[44:47]
    ds_read_b64_tr_b16 v[140:141], v203 offset:0
    v_mfma_f32_16x16x32_bf16 v[60:63], v[172:175], v[188:191], v[60:63]
    ds_read_b64_tr_b16 v[142:143], v203 offset:1024
    v_mfma_f32_16x16x32_bf16 v[0:3], v[64:67], v[80:83], v[0:3]
    ds_read_b128 v[144:147], v204 offset:0
    v_mfma_f32_16x16x32_bf16 v[16:19], v[68:71], v[80:83], v[16:19]
    ds_read_b128 v[148:151], v204 offset:2048
    v_mfma_f32_16x16x32_bf16 v[32:35], v[72:75], v[80:83], v[32:35]
    ds_read_b128 v[152:155], v204 offset:4096
    v_mfma_f32_16x16x32_bf16 v[48:51], v[76:79], v[80:83], v[48:51]
    ds_read_b128 v[156:159], v204 offset:6144
    v_mfma_f32_16x16x32_bf16 v[4:7], v[64:67], v[84:87], v[4:7]
    ds_read_b64_tr_b16 v[160:161], v200 offset:8192
    v_mfma_f32_16x16x32_bf16 v[20:23], v[68:71], v[84:87], v[20:23]
    ds_read_b64_tr_b16 v[162:163], v200 offset:9216
    v_mfma_f32_16x16x32_bf16 v[36:39], v[72:75], v[84:87], v[36:39]
    ds_read_b64_tr_b16 v[164:165], v201 offset:8192
    v_mfma_f32_16x16x32_bf16 v[52:55], v[76:79], v[84:87], v[52:55]
    ds_read_b64_tr_b16 v[166:167], v201 offset:9216
    v_mfma_f32_16x16x32_bf16 v[8:11], v[64:67], v[88:91], v[8:11]
    ds_read_b64_tr_b16 v[168:169], v202 offset:8192
    v_mfma_f32_16x16x32_bf16 v[24:27], v[68:71], v[88:91], v[24:27]
    ds_read_b64_tr_b16 v[170:171], v202 offset:9216
    v_mfma_f32_16x16x32_bf16 v[40:43], v[72:75], v[88:91], v[40:43]
    ds_read_b64_tr_b16 v[172:173], v203 offset:8192
    v_mfma_f32_16x16x32_bf16 v[56:59], v[76:79], v[88:91], v[56:59]
    ds_read_b64_tr_b16 v[174:175], v203 offset:9216
    v_mfma_f32_16x16x32_bf16 v[12:15], v[64:67], v[92:95], v[12:15]
    ds_read_b128 v[176:179], v205 offset:0
    v_mfma_f32_16x16x32_bf16 v[28:31], v[68:71], v[92:95], v[28:31]
    ds_read_b128 v[180:183], v205 offset:2048
    v_mfma_f32_16x16x32_bf16 v[44:47], v[72:75], v[92:95], v[44:47]
    ds_read_b128 v[184:187], v205 offset:4096
    v_mfma_f32_16x16x32_bf16 v[60:63], v[76:79], v[92:95], v[60:63]
    ds_read_b128 v[188:191], v205 offset:6144
    v_mfma_f32_16x16x32_bf16 v[0:3], v[96:99], v[112:115], v[0:3]
    v_mfma_f32_16x16x32_bf16 v[16:19], v[100:103], v[112:115], v[16:19]
    v_mfma_f32_16x16x32_bf16 v[32:35], v[104:107], v[112:115], v[32:35]
    v_mfma_f32_16x16x32_bf16 v[48:51], v[108:111], v[112:115], v[48:51]
    v_mfma_f32_16x16x32_bf16 v[4:7], v[96:99], v[116:119], v[4:7]
    v_mfma_f32_16x16x32_bf16 v[20:23], v[100:103], v[116:119], v[20:23]
    v_mfma_f32_16x16x32_bf16 v[36:39], v[104:107], v[116:119], v[36:39]
    v_mfma_f32_16x16x32_bf16 v[52:55], v[108:111], v[116:119], v[52:55]
    s_waitcnt lgkmcnt(0)
    v_mfma_f32_16x16x32_bf16 v[8:11], v[96:99], v[120:123], v[8:11]
    v_mfma_f32_16x16x32_bf16 v[24:27], v[100:103], v[120:123], v[24:27]
    v_mfma_f32_16x16x32_bf16 v[40:43], v[104:107], v[120:123], v[40:43]
    v_mfma_f32_16x16x32_bf16 v[56:59], v[108:111], v[120:123], v[56:59]
    v_mfma_f32_16x16x32_bf16 v[12:15], v[96:99], v[124:127], v[12:15]
    v_mfma_f32_16x16x32_bf16 v[28:31], v[100:103], v[124:127], v[28:31]
    v_mfma_f32_16x16x32_bf16 v[44:47], v[104:107], v[124:127], v[44:47]
    v_mfma_f32_16x16x32_bf16 v[60:63], v[108:111], v[124:127], v[60:63]
    v_mfma_f32_16x16x32_bf16 v[0:3], v[128:131], v[144:147], v[0:3]
    v_mfma_f32_16x16x32_bf16 v[16:19], v[132:135], v[144:147], v[16:19]
    v_mfma_f32_16x16x32_bf16 v[32:35], v[136:139], v[144:147], v[32:35]
    v_mfma_f32_16x16x32_bf16 v[48:51], v[140:143], v[144:147], v[48:51]
    v_mfma_f32_16x16x32_bf16 v[4:7], v[128:131], v[148:151], v[4:7]
    v_mfma_f32_16x16x32_bf16 v[20:23], v[132:135], v[148:151], v[20:23]
    v_mfma_f32_16x16x32_bf16 v[36:39], v[136:139], v[148:151], v[36:39]
    v_mfma_f32_16x16x32_bf16 v[52:55], v[140:143], v[148:151], v[52:55]
    v_mfma_f32_16x16x32_bf16 v[8:11], v[128:131], v[152:155], v[8:11]
    v_mfma_f32_16x16x32_bf16 v[24:27], v[132:135], v[152:155], v[24:27]
    v_mfma_f32_16x16x32_bf16 v[40:43], v[136:139], v[152:155], v[40:43]
    v_mfma_f32_16x16x32_bf16 v[56:59], v[140:143], v[152:155], v[56:59]
    v_mfma_f32_16x16x32_bf16 v[12:15], v[128:131], v[156:159], v[12:15]
    v_mfma_f32_16x16x32_bf16 v[28:31], v[132:135], v[156:159], v[28:31]
    v_mfma_f32_16x16x32_bf16 v[44:47], v[136:139], v[156:159], v[44:47]
    v_mfma_f32_16x16x32_bf16 v[60:63], v[140:143], v[156:159], v[60:63]
    v_mfma_f32_16x16x32_bf16 v[0:3], v[160:163], v[176:179], v[0:3]
    v_mfma_f32_16x16x32_bf16 v[16:19], v[164:167], v[176:179], v[16:19]
    v_mfma_f32_16x16x32_bf16 v[32:35], v[168:171], v[176:179], v[32:35]
    v_mfma_f32_16x16x32_bf16 v[48:51], v[172:175], v[176:179], v[48:51]
    v_mfma_f32_16x16x32_bf16 v[4:7], v[160:163], v[180:183], v[4:7]
    v_mfma_f32_16x16x32_bf16 v[20:23], v[164:167], v[180:183], v[20:23]
    v_mfma_f32_16x16x32_bf16 v[36:39], v[168:171], v[180:183], v[36:39]
    v_mfma_f32_16x16x32_bf16 v[52:55], v[172:175], v[180:183], v[52:55]
    v_mfma_f32_16x16x32_bf16 v[8:11], v[160:163], v[184:187], v[8:11]
    v_mfma_f32_16x16x32_bf16 v[24:27], v[164:167], v[184:187], v[24:27]
    v_mfma_f32_16x16x32_bf16 v[40:43], v[168:171], v[184:187], v[40:43]
    v_mfma_f32_16x16x32_bf16 v[56:59], v[172:175], v[184:187], v[56:59]
    v_mfma_f32_16x16x32_bf16 v[12:15], v[160:163], v[188:191], v[12:15]
    v_mfma_f32_16x16x32_bf16 v[28:31], v[164:167], v[188:191], v[28:31]
    v_mfma_f32_16x16x32_bf16 v[44:47], v[168:171], v[188:191], v[44:47]
    v_mfma_f32_16x16x32_bf16 v[60:63], v[172:175], v[188:191], v[60:63]
    s_cmp_eq_u32 s15, 0
    s_nop 5
    s_cbranch_scc0 L_epineg
    v_cvt_pk_bf16_f32 v64, v0, v1
    v_cvt_pk_bf16_f32 v65, v2, v3
    v_cvt_pk_bf16_f32 v66, v16, v17
    v_cvt_pk_bf16_f32 v67, v18, v19
    v_cvt_pk_bf16_f32 v68, v32, v33
    v_cvt_pk_bf16_f32 v69, v34, v35
    v_cvt_pk_bf16_f32 v70, v48, v49
    v_cvt_pk_bf16_f32 v71, v50, v51
    v_permlane16_swap_b32 v64, v66
    v_permlane16_swap_b32 v65, v67
    v_permlane16_swap_b32 v68, v70
    v_permlane16_swap_b32 v69, v71
    v_mov_b32 v96, v64
    v_mov_b32 v97, v65
    v_mov_b32 v98, v66
    v_mov_b32 v99, v67
    s_nop 1
    v_mov_b32_dpp v64, v68 row_ror:8 row_mask:0xf bank_mask:0xc
    v_mov_b32_dpp v65, v69 row_ror:8 row_mask:0xf bank_mask:0xc
    v_mov_b32_dpp v66, v70 row_ror:8 row_mask:0xf bank_mask:0xc
    v_mov_b32_dpp v67, v71 row_ror:8 row_mask:0xf bank_mask:0xc
    v_mov_b32_dpp v68, v96 row_ror:8 row_mask:0xf bank_mask:0x3
    v_mov_b32_dpp v69, v97 row_ror:8 row_mask:0xf bank_mask:0x3
    v_mov_b32_dpp v70, v98 row_ror:8 row_mask:0xf bank_mask:0x3
    v_mov_b32_dpp v71, v99 row_ror:8 row_mask:0xf bank_mask:0x3
    buffer_store_dwordx4 v[64:67], v217, s[24:27], s44 offen offset:0 sc1
    buffer_store_dwordx4 v[68:71], v218, s[24:27], s44 offen offset:0 sc1
    v_cvt_pk_bf16_f32 v72, v4, v5
    v_cvt_pk_bf16_f32 v73, v6, v7
    v_cvt_pk_bf16_f32 v74, v20, v21
    v_cvt_pk_bf16_f32 v75, v22, v23
    v_cvt_pk_bf16_f32 v76, v36, v37
    v_cvt_pk_bf16_f32 v77, v38, v39
    v_cvt_pk_bf16_f32 v78, v52, v53
    v_cvt_pk_bf16_f32 v79, v54, v55
    v_permlane16_swap_b32 v72, v74
    v_permlane16_swap_b32 v73, v75
    v_permlane16_swap_b32 v76, v78
    v_permlane16_swap_b32 v77, v79
    v_mov_b32 v100, v72
    v_mov_b32 v101, v73
    v_mov_b32 v102, v74
    v_mov_b32 v103, v75
    s_nop 1
    v_mov_b32_dpp v72, v76 row_ror:8 row_mask:0xf bank_mask:0xc
    v_mov_b32_dpp v73, v77 row_ror:8 row_mask:0xf bank_mask:0xc
    v_mov_b32_dpp v74, v78 row_ror:8 row_mask:0xf bank_mask:0xc
    v_mov_b32_dpp v75, v79 row_ror:8 row_mask:0xf bank_mask:0xc
    v_mov_b32_dpp v76, v100 row_ror:8 row_mask:0xf bank_mask:0x3
    v_mov_b32_dpp v77, v101 row_ror:8 row_mask:0xf bank_mask:0x3
    v_mov_b32_dpp v78, v102 row_ror:8 row_mask:0xf bank_mask:0x3
    v_mov_b32_dpp v79, v103 row_ror:8 row_mask:0xf bank_mask:0x3
    buffer_store_dwordx4 v[72:75], v217, s[24:27], s44 offen offset:2048 sc1
    buffer_store_dwordx4 v[76:79], v218, s[24:27], s44 offen offset:2048 sc1
    v_cvt_pk_bf16_f32 v80, v8, v9
    v_cvt_pk_bf16_f32 v81, v10, v11
    v_cvt_pk_bf16_f32 v82, v24, v25
    v_cvt_pk_bf16_f32 v83, v26, v27
    v_cvt_pk_bf16_f32 v84, v40, v41
    v_cvt_pk_bf16_f32 v85, v42, v43
    v_cvt_pk_bf16_f32 v86, v56, v57
    v_cvt_pk_bf16_f32 v87, v58, v59
    v_permlane16_swap_b32 v80, v82
    v_permlane16_swap_b32 v81, v83
    v_permlane16_swap_b32 v84, v86
    v_permlane16_swap_b32 v85, v87
    v_mov_b32 v104, v80
    v_mov_b32 v105, v81
    v_mov_b32 v106, v82
    v_mov_b32 v107, v83
    s_nop 1
    v_mov_b32_dpp v80, v84 row_ror:8 row_mask:0xf bank_mask:0xc
    v_mov_b32_dpp v81, v85 row_ror:8 row_mask:0xf bank_mask:0xc
    v_mov_b32_dpp v82, v86 row_ror:8 row_mask:0xf bank_mask:0xc
    v_mov_b32_dpp v83, v87 row_ror:8 row_mask:0xf bank_mask:0xc
    v_mov_b32_dpp v84, v104 row_ror:8 row_mask:0xf bank_mask:0x3
    v_mov_b32_dpp v85, v105 row_ror:8 row_mask:0xf bank_mask:0x3
    v_mov_b32_dpp v86, v106 row_ror:8 row_mask:0xf bank_mask:0x3
    v_mov_b32_dpp v87, v107 row_ror:8 row_mask:0xf bank_mask:0x3
    buffer_store_dwordx4 v[80:83], v217, s[24:27], s45 offen offset:0 sc1
    buffer_store_dwordx4 v[84:87], v218, s[24:27], s45 offen offset:0 sc1
    v_cvt_pk_bf16_f32 v88, v12, v13
    v_cvt_pk_bf16_f32 v89, v14, v15
    v_cvt_pk_bf16_f32 v90, v28, v29
    v_cvt_pk_bf16_f32 v91, v30, v31
    v_cvt_pk_bf16_f32 v92, v44, v45
    v_cvt_pk_bf16_f32 v93, v46, v47
    v_cvt_pk_bf16_f32 v94, v60, v61
    v_cvt_pk_bf16_f32 v95, v62, v63
    v_permlane16_swap_b32 v88, v90
    v_permlane16_swap_b32 v89, v91
    v_permlane16_swap_b32 v92, v94
    v_permlane16_swap_b32 v93, v95
    v_mov_b32 v108, v88
    v_mov_b32 v109, v89
    v_mov_b32 v110, v90
    v_mov_b32 v111, v91
    s_nop 1
    v_mov_b32_dpp v88, v92 row_ror:8 row_mask:0xf bank_mask:0xc
    v_mov_b32_dpp v89, v93 row_ror:8 row_mask:0xf bank_mask:0xc
    v_mov_b32_dpp v90, v94 row_ror:8 row_mask:0xf bank_mask:0xc
    v_mov_b32_dpp v91, v95 row_ror:8 row_mask:0xf bank_mask:0xc
    v_mov_b32_dpp v92, v108 row_ror:8 row_mask:0xf bank_mask:0x3
    v_mov_b32_dpp v93, v109 row_ror:8 row_mask:0xf bank_mask:0x3
    v_mov_b32_dpp v94, v110 row_ror:8 row_mask:0xf bank_mask:0x3
    v_mov_b32_dpp v95, v111 row_ror:8 row_mask:0xf bank_mask:0x3
    buffer_store_dwordx4 v[88:91], v217, s[24:27], s45 offen offset:2048 sc1
    buffer_store_dwordx4 v[92:95], v218, s[24:27], s45 offen offset:2048 sc1
    s_branch L_epidone
L_epineg:
    v_cvt_pk_bf16_f32 v64, -v0, -v1
    v_cvt_pk_bf16_f32 v65, -v2, -v3
    v_cvt_pk_bf16_f32 v66, -v16, -v17
    v_cvt_pk_bf16_f32 v67, -v18, -v19
    v_cvt_pk_bf16_f32 v68, -v32, -v33
    v_cvt_pk_bf16_f32 v69, -v34, -v35
    v_cvt_pk_bf16_f32 v70, -v48, -v49
    v_cvt_pk_bf16_f32 v71, -v50, -v51
    v_permlane16_swap_b32 v64, v66
    v_permlane16_swap_b32 v65, v67
    v_permlane16_swap_b32 v68, v70
    v_permlane16_swap_b32 v69, v71
    v_mov_b32 v96, v64
    v_mov_b32 v97, v65
    v_mov_b32 v98, v66
    v_mov_b32 v99, v67
    s_nop 1
    v_mov_b32_dpp v64, v68 row_ror:8 row_mask:0xf bank_mask:0xc
    v_mov_b32_dpp v65, v69 row_ror:8 row_mask:0xf bank_mask:0xc
    v_mov_b32_dpp v66, v70 row_ror:8 row_mask:0xf bank_mask:0xc
    v_mov_b32_dpp v67, v71 row_ror:8 row_mask:0xf bank_mask:0xc
    v_mov_b32_dpp v68, v96 row_ror:8 row_mask:0xf bank_mask:0x3
    v_mov_b32_dpp v69, v97 row_ror:8 row_mask:0xf bank_mask:0x3
    v_mov_b32_dpp v70, v98 row_ror:8 row_mask:0xf bank_mask:0x3
    v_mov_b32_dpp v71, v99 row_ror:8 row_mask:0xf bank_mask:0x3
    buffer_store_dwordx4 v[64:67], v217, s[24:27], s44 offen offset:0 sc1
    buffer_store_dwordx4 v[68:71], v218, s[24:27], s44 offen offset:0 sc1
    v_cvt_pk_bf16_f32 v72, -v4, -v5
    v_cvt_pk_bf16_f32 v73, -v6, -v7
    v_cvt_pk_bf16_f32 v74, -v20, -v21
    v_cvt_pk_bf16_f32 v75, -v22, -v23
    v_cvt_pk_bf16_f32 v76, -v36, -v37
    v_cvt_pk_bf16_f32 v77, -v38, -v39
    v_cvt_pk_bf16_f32 v78, -v52, -v53
    v_cvt_pk_bf16_f32 v79, -v54, -v55
    v_permlane16_swap_b32 v72, v74
    v_permlane16_swap_b32 v73, v75
    v_permlane16_swap_b32 v76, v78
    v_permlane16_swap_b32 v77, v79
    v_mov_b32 v100, v72
    v_mov_b32 v101, v73
    v_mov_b32 v102, v74
    v_mov_b32 v103, v75
    s_nop 1
    v_mov_b32_dpp v72, v76 row_ror:8 row_mask:0xf bank_mask:0xc
    v_mov_b32_dpp v73, v77 row_ror:8 row_mask:0xf bank_mask:0xc
    v_mov_b32_dpp v74, v78 row_ror:8 row_mask:0xf bank_mask:0xc
    v_mov_b32_dpp v75, v79 row_ror:8 row_mask:0xf bank_mask:0xc
    v_mov_b32_dpp v76, v100 row_ror:8 row_mask:0xf bank_mask:0x3
    v_mov_b32_dpp v77, v101 row_ror:8 row_mask:0xf bank_mask:0x3
    v_mov_b32_dpp v78, v102 row_ror:8 row_mask:0xf bank_mask:0x3
    v_mov_b32_dpp v79, v103 row_ror:8 row_mask:0xf bank_mask:0x3
    buffer_store_dwordx4 v[72:75], v217, s[24:27], s44 offen offset:2048 sc1
    buffer_store_dwordx4 v[76:79], v218, s[24:27], s44 offen offset:2048 sc1
    v_cvt_pk_bf16_f32 v80, -v8, -v9
    v_cvt_pk_bf16_f32 v81, -v10, -v11
    v_cvt_pk_bf16_f32 v82, -v24, -v25
    v_cvt_pk_bf16_f32 v83, -v26, -v27
    v_cvt_pk_bf16_f32 v84, -v40, -v41
    v_cvt_pk_bf16_f32 v85, -v42, -v43
    v_cvt_pk_bf16_f32 v86, -v56, -v57
    v_cvt_pk_bf16_f32 v87, -v58, -v59
    v_permlane16_swap_b32 v80, v82
    v_permlane16_swap_b32 v81, v83
    v_permlane16_swap_b32 v84, v86
    v_permlane16_swap_b32 v85, v87
    v_mov_b32 v104, v80
    v_mov_b32 v105, v81
    v_mov_b32 v106, v82
    v_mov_b32 v107, v83
    s_nop 1
    v_mov_b32_dpp v80, v84 row_ror:8 row_mask:0xf bank_mask:0xc
    v_mov_b32_dpp v81, v85 row_ror:8 row_mask:0xf bank_mask:0xc
    v_mov_b32_dpp v82, v86 row_ror:8 row_mask:0xf bank_mask:0xc
    v_mov_b32_dpp v83, v87 row_ror:8 row_mask:0xf bank_mask:0xc
    v_mov_b32_dpp v84, v104 row_ror:8 row_mask:0xf bank_mask:0x3
    v_mov_b32_dpp v85, v105 row_ror:8 row_mask:0xf bank_mask:0x3
    v_mov_b32_dpp v86, v106 row_ror:8 row_mask:0xf bank_mask:0x3
    v_mov_b32_dpp v87, v107 row_ror:8 row_mask:0xf bank_mask:0x3
    buffer_store_dwordx4 v[80:83], v217, s[24:27], s45 offen offset:0 sc1
    buffer_store_dwordx4 v[84:87], v218, s[24:27], s45 offen offset:0 sc1
    v_cvt_pk_bf16_f32 v88, -v12, -v13
    v_cvt_pk_bf16_f32 v89, -v14, -v15
    v_cvt_pk_bf16_f32 v90, -v28, -v29
    v_cvt_pk_bf16_f32 v91, -v30, -v31
    v_cvt_pk_bf16_f32 v92, -v44, -v45
    v_cvt_pk_bf16_f32 v93, -v46, -v47
    v_cvt_pk_bf16_f32 v94, -v60, -v61
    v_cvt_pk_bf16_f32 v95, -v62, -v63
    v_permlane16_swap_b32 v88, v90
    v_permlane16_swap_b32 v89, v91
    v_permlane16_swap_b32 v92, v94
    v_permlane16_swap_b32 v93, v95
    v_mov_b32 v108, v88
    v_mov_b32 v109, v89
    v_mov_b32 v110, v90
    v_mov_b32 v111, v91
    s_nop 1
    v_mov_b32_dpp v88, v92 row_ror:8 row_mask:0xf bank_mask:0xc
    v_mov_b32_dpp v89, v93 row_ror:8 row_mask:0xf bank_mask:0xc
    v_mov_b32_dpp v90, v94 row_ror:8 row_mask:0xf bank_mask:0xc
    v_mov_b32_dpp v91, v95 row_ror:8 row_mask:0xf bank_mask:0xc
    v_mov_b32_dpp v92, v108 row_ror:8 row_mask:0xf bank_mask:0x3
    v_mov_b32_dpp v93, v109 row_ror:8 row_mask:0xf bank_mask:0x3
    v_mov_b32_dpp v94, v110 row_ror:8 row_mask:0xf bank_mask:0x3
    v_mov_b32_dpp v95, v111 row_ror:8 row_mask:0xf bank_mask:0x3
    buffer_store_dwordx4 v[88:91], v217, s[24:27], s45 offen offset:2048 sc1
    buffer_store_dwordx4 v[92:95], v218, s[24:27], s45 offen offset:2048 sc1
L_epidone:
    s_lshl_b32 s33, s28, 13
    s_lshl_b32 s34, s29, 12
    s_add_u32 s34, s34, 16384
    v_lshrrev_b32 v209, 4, v208
    v_bfe_u32 v210, v208, 1, 3
    v_xor_b32 v210, v210, v209
    v_and_b32 v209, 15, v208
    v_lshlrev_b32 v209, 7, v209
    v_add_u32 v209, s33, v209
    v_xor_b32 v211, 0, v210
    v_lshl_add_u32 v192, v211, 4, v209
    v_xor_b32 v211, 4, v210
    v_lshl_add_u32 v193, v211, 4, v209
    v_lshrrev_b32 v209, 4, v208
    v_bfe_u32 v210, v208, 1, 3
    v_xor_b32 v210, v210, v209
    v_and_b32 v209, 15, v208
    v_lshlrev_b32 v209, 7, v209
    v_add_u32 v209, s34, v209
    v_xor_b32 v211, 0, v210
    v_lshl_add_u32 v194, v211, 4, v209
    v_xor_b32 v211, 4, v210
    v_lshl_add_u32 v195, v211, 4, v209
    v_mov_b32 v0, 0
    v_mov_b32 v1, 0
    v_mov_b32 v2, 0
    v_mov_b32 v3, 0
    v_mov_b32 v4, 0
    v_mov_b32 v5, 0
    v_mov_b32 v6, 0
    v_mov_b32 v7, 0
    v_mov_b32 v8, 0
    v_mov_b32 v9, 0
    v_mov_b32 v10, 0
    v_mov_b32 v11, 0
    v_mov_b32 v12, 0
    v_mov_b32 v13, 0
    v_mov_b32 v14, 0
    v_mov_b32 v15, 0
    v_mov_b32 v16, 0
    v_mov_b32 v17, 0
    v_mov_b32 v18, 0
    v_mov_b32 v19, 0
    v_mov_b32 v20, 0
    v_mov_b32 v21, 0
    v_mov_b32 v22, 0
    v_mov_b32 v23, 0
    v_mov_b32 v24, 0
    v_mov_b32 v25, 0
    v_mov_b32 v26, 0
    v_mov_b32 v27, 0
    v_mov_b32 v28, 0
    v_mov_b32 v29, 0
    v_mov_b32 v30, 0
    v_mov_b32 v31, 0
    s_lshl_b32 s30, s13, 1
    s_add_u32 s30, s30, s15
    s_lshl_b32 s30, s30, 6
    s_lshl_b32 s31, s29, 5
    s_add_u32 s30, s30, s31
    s_lshl_b32 s30, s30, 11
    s_lshl_b32 s31, s14, 8
    s_add_u32 s30, s30, s31
    s_lshl_b32 s31, s28, 7
    s_add_u32 s44, s30, s31
    s_add_u32 s45, s44, 32768
    v_and_b32 v211, 7, v208
    v_lshlrev_b32 v214, 11, v211
    v_lshl_add_u32 v214, v219, 4, v214
    v_add_u32 v213, 16384, v214
    s_waitcnt vmcnt(0)
    s_barrier
    s_barrier
    v_add_u32 v200, s40, v192
    v_add_u32 v201, s40, v193
    v_add_u32 v202, s40, v194
    v_add_u32 v203, s40, v195
    s_add_u32 s40, s40, 32768
    s_cmp_eq_u32 s40, 163840
    s_cselect_b32 s40, 0, s40
    s_barrier
    ds_read_b128 v[96:99], v200 offset:0
    ds_read_b128 v[100:103], v200 offset:2048
    ds_read_b128 v[104:107], v200 offset:4096
    ds_read_b128 v[108:111], v200 offset:6144
    ds_read_b128 v[112:115], v202 offset:0
    ds_read_b128 v[116:119], v202 offset:2048
    ds_read_b128 v[120:123], v201 offset:0
    ds_read_b128 v[124:127], v201 offset:2048
    ds_read_b128 v[128:131], v201 offset:4096
    ds_read_b128 v[132:135], v201 offset:6144
    ds_read_b128 v[136:139], v203 offset:0
    ds_read_b128 v[140:143], v203 offset:2048
    v_add_u32 v200, s40, v192
    v_add_u32 v201, s40, v193
    v_add_u32 v202, s40, v194
    v_add_u32 v203, s40, v195
    s_add_u32 s40, s40, 32768
    s_cmp_eq_u32 s40, 163840
    s_cselect_b32 s40, 0, s40
    s_mov_b32 s41, 14
    s_waitcnt lgkmcnt(0)
    s_barrier
    v_mfma_f32_16x16x32_bf16 v[0:3], v[96:99], v[112:115], v[0:3]
    ds_read_b128 v[144:147], v200 offset:0
    ds_read_b128 v[148:151], v200 offset:2048
    v_mfma_f32_16x16x32_bf16 v[8:11], v[100:103], v[112:115], v[8:11]
    ds_read_b128 v[152:155], v200 offset:4096
    v_mfma_f32_16x16x32_bf16 v[16:19], v[104:107], v[112:115], v[16:19]
    ds_read_b128 v[156:159], v200 offset:6144
    ds_read_b128 v[160:163], v202 offset:0
    v_mfma_f32_16x16x32_bf16 v[24:27], v[108:111], v[112:115], v[24:27]
    ds_read_b128 v[164:167], v202 offset:2048
    v_mfma_f32_16x16x32_bf16 v[4:7], v[96:99], v[116:119], v[4:7]
    ds_read_b128 v[168:171], v201 offset:0
    ds_read_b128 v[172:175], v201 offset:2048
    v_mfma_f32_16x16x32_bf16 v[12:15], v[100:103], v[116:119], v[12:15]
    ds_read_b128 v[176:179], v201 offset:4096
    v_mfma_f32_16x16x32_bf16 v[20:23], v[104:107], v[116:119], v[20:23]
    ds_read_b128 v[180:183], v201 offset:6144
    ds_read_b128 v[184:187], v203 offset:0
    v_mfma_f32_16x16x32_bf16 v[28:31], v[108:111], v[116:119], v[28:31]
    ds_read_b128 v[188:191], v203 offset:2048
    v_mfma_f32_16x16x32_bf16 v[0:3], v[120:123], v[136:139], v[0:3]
    v_add_u32 v200, s40, v192
    v_add_u32 v201, s40, v193
    v_add_u32 v202, s40, v194
    v_mfma_f32_16x16x32_bf16 v[8:11], v[124:127], v[136:139], v[8:11]
    v_add_u32 v203, s40, v195
    s_add_u32 s40, s40, 32768
    v_mfma_f32_16x16x32_bf16 v[16:19], v[128:131], v[136:139], v[16:19]
    s_cmp_eq_u32 s40, 163840
    s_cselect_b32 s40, 0, s40
    v_mfma_f32_16x16x32_bf16 v[24:27], v[132:135], v[136:139], v[24:27]
L_s2_cloop:
    s_waitcnt lgkmcnt(0)
    s_barrier
    v_mfma_f32_16x16x32_bf16 v[4:7], v[120:123], v[140:143], v[4:7]
    ds_read_b128 v[96:99], v200 offset:0
    v_mfma_f32_16x16x32_bf16 v[12:15], v[124:127], v[140:143], v[12:15]
    ds_read_b128 v[100:103], v200 offset:2048
    v_mfma_f32_16x16x32_bf16 v[20:23], v[128:131], v[140:143], v[20:23]
    ds_read_b128 v[104:107], v200 offset:4096
    v_mfma_f32_16x16x32_bf16 v[28:31], v[132:135], v[140:143], v[28:31]
    ds_read_b128 v[108:111], v200 offset:6144
    v_mfma_f32_16x16x32_bf16 v[0:3], v[144:147], v[160:163], v[0:3]
    ds_read_b128 v[112:115], v202 offset:0
    v_mfma_f32_16x16x32_bf16 v[8:11], v[148:151], v[160:163], v[8:11]
    ds_read_b128 v[116:119], v202 offset:2048
    v_mfma_f32_16x16x32_bf16 v[16:19], v[152:155], v[160:163], v[16:19]
    ds_read_b128 v[120:123], v201 offset:0
    v_mfma_f32_16x16x32_bf16 v[24:27], v[156:159], v[160:163], v[24:27]
    ds_read_b128 v[124:127], v201 offset:2048
    v_mfma_f32_16x16x32_bf16 v[4:7], v[144:147], v[164:167], v[4:7]
    ds_read_b128 v[128:131], v201 offset:4096
    v_mfma_f32_16x16x32_bf16 v[12:15], v[148:151], v[164:167], v[12:15]
    ds_read_b128 v[132:135], v201 offset:6144
    v_mfma_f32_16x16x32_bf16 v[20:23], v[152:155], v[164:167], v[20:23]
    ds_read_b128 v[136:139], v203 offset:0
    v_mfma_f32_16x16x32_bf16 v[28:31], v[156:159], v[164:167], v[28:31]
    ds_read_b128 v[140:143], v203 offset:2048
    v_mfma_f32_16x16x32_bf16 v[0:3], v[168:171], v[184:187], v[0:3]
    v_add_u32 v200, s40, v192
    v_add_u32 v201, s40, v193
    v_add_u32 v202, s40, v194
    v_mfma_f32_16x16x32_bf16 v[8:11], v[172:175], v[184:187], v[8:11]
    v_add_u32 v203, s40, v195
    s_add_u32 s40, s40, 32768
    v_mfma_f32_16x16x32_bf16 v[16:19], v[176:179], v[184:187], v[16:19]
    s_cmp_eq_u32 s40, 163840
    s_cselect_b32 s40, 0, s40
    v_mfma_f32_16x16x32_bf16 v[24:27], v[180:183], v[184:187], v[24:27]
    s_waitcnt lgkmcnt(0)
    s_barrier
    v_mfma_f32_16x16x32_bf16 v[4:7], v[168:171], v[188:191], v[4:7]
    ds_read_b128 v[144:147], v200 offset:0
    v_mfma_f32_16x16x32_bf16 v[12:15], v[172:175], v[188:191], v[12:15]
    ds_read_b128 v[148:151], v200 offset:2048
    v_mfma_f32_16x16x32_bf16 v[20:23], v[176:179], v[188:191], v[20:23]
    ds_read_b128 v[152:155], v200 offset:4096
    v_mfma_f32_16x16x32_bf16 v[28:31], v[180:183], v[188:191], v[28:31]
    ds_read_b128 v[156:159], v200 offset:6144
    v_mfma_f32_16x16x32_bf16 v[0:3], v[96:99], v[112:115], v[0:3]
    ds_read_b128 v[160:163], v202 offset:0
    v_mfma_f32_16x16x32_bf16 v[8:11], v[100:103], v[112:115], v[8:11]
    ds_read_b128 v[164:167], v202 offset:2048
    v_mfma_f32_16x16x32_bf16 v[16:19], v[104:107], v[112:115], v[16:19]
    ds_read_b128 v[168:171], v201 offset:0
    v_mfma_f32_16x16x32_bf16 v[24:27], v[108:111], v[112:115], v[24:27]
    ds_read_b128 v[172:175], v201 offset:2048
    v_mfma_f32_16x16x32_bf16 v[4:7], v[96:99], v[116:119], v[4:7]
    ds_read_b128 v[176:179], v201 offset:4096
    v_mfma_f32_16x16x32_bf16 v[12:15], v[100:103], v[116:119], v[12:15]
    ds_read_b128 v[180:183], v201 offset:6144
    v_mfma_f32_16x16x32_bf16 v[20:23], v[104:107], v[116:119], v[20:23]
    ds_read_b128 v[184:187], v203 offset:0
    v_mfma_f32_16x16x32_bf16 v[28:31], v[108:111], v[116:119], v[28:31]
    ds_read_b128 v[188:191], v203 offset:2048
    v_mfma_f32_16x16x32_bf16 v[0:3], v[120:123], v[136:139], v[0:3]
    v_add_u32 v200, s40, v192
    v_add_u32 v201, s40, v193
    v_add_u32 v202, s40, v194
    v_mfma_f32_16x16x32_bf16 v[8:11], v[124:127], v[136:139], v[8:11]
    v_add_u32 v203, s40, v195
    s_add_u32 s40, s40, 32768
    s_cmp_eq_u32 s40, 163840
    v_mfma_f32_16x16x32_bf16 v[16:19], v[128:131], v[136:139], v[16:19]
    s_cselect_b32 s40, 0, s40
    s_sub_u32 s41, s41, 1
    s_cmp_lg_u32 s41, 0
    v_mfma_f32_16x16x32_bf16 v[24:27], v[132:135], v[136:139], v[24:27]
    s_cbranch_scc1 L_s2_cloop
    s_waitcnt lgkmcnt(0)
    s_barrier
    v_mfma_f32_16x16x32_bf16 v[4:7], v[120:123], v[140:143], v[4:7]
    ds_read_b128 v[96:99], v200 offset:0
    v_mfma_f32_16x16x32_bf16 v[12:15], v[124:127], v[140:143], v[12:15]
    ds_read_b128 v[100:103], v200 offset:2048
    v_mfma_f32_16x16x32_bf16 v[20:23], v[128:131], v[140:143], v[20:23]
    ds_read_b128 v[104:107], v200 offset:4096
    v_mfma_f32_16x16x32_bf16 v[28:31], v[132:135], v[140:143], v[28:31]
    ds_read_b128 v[108:111], v200 offset:6144
    v_mfma_f32_16x16x32_bf16 v[0:3], v[144:147], v[160:163], v[0:3]
    ds_read_b128 v[112:115], v202 offset:0
    v_mfma_f32_16x16x32_bf16 v[8:11], v[148:151], v[160:163], v[8:11]
    ds_read_b128 v[116:119], v202 offset:2048
    v_mfma_f32_16x16x32_bf16 v[16:19], v[152:155], v[160:163], v[16:19]
    ds_read_b128 v[120:123], v201 offset:0
    v_mfma_f32_16x16x32_bf16 v[24:27], v[156:159], v[160:163], v[24:27]
    ds_read_b128 v[124:127], v201 offset:2048
    v_mfma_f32_16x16x32_bf16 v[4:7], v[144:147], v[164:167], v[4:7]
    ds_read_b128 v[128:131], v201 offset:4096
    v_mfma_f32_16x16x32_bf16 v[12:15], v[148:151], v[164:167], v[12:15]
    ds_read_b128 v[132:135], v201 offset:6144
    v_mfma_f32_16x16x32_bf16 v[20:23], v[152:155], v[164:167], v[20:23]
    ds_read_b128 v[136:139], v203 offset:0
    v_mfma_f32_16x16x32_bf16 v[28:31], v[156:159], v[164:167], v[28:31]
    ds_read_b128 v[140:143], v203 offset:2048
    v_mfma_f32_16x16x32_bf16 v[0:3], v[168:171], v[184:187], v[0:3]
    v_add_u32 v200, s40, v192
    v_add_u32 v201, s40, v193
    v_add_u32 v202, s40, v194
    v_mfma_f32_16x16x32_bf16 v[8:11], v[172:175], v[184:187], v[8:11]
    v_add_u32 v203, s40, v195
    s_add_u32 s40, s40, 32768
    v_mfma_f32_16x16x32_bf16 v[16:19], v[176:179], v[184:187], v[16:19]
    s_cmp_eq_u32 s40, 163840
    s_cselect_b32 s40, 0, s40
    v_mfma_f32_16x16x32_bf16 v[24:27], v[180:183], v[184:187], v[24:27]
    s_waitcnt lgkmcnt(0)
    s_barrier
    v_mfma_f32_16x16x32_bf16 v[4:7], v[168:171], v[188:191], v[4:7]
    ds_read_b128 v[144:147], v200 offset:0
    v_mfma_f32_16x16x32_bf16 v[12:15], v[172:175], v[188:191], v[12:15]
    ds_read_b128 v[148:151], v200 offset:2048
    v_mfma_f32_16x16x32_bf16 v[20:23], v[176:179], v[188:191], v[20:23]
    ds_read_b128 v[152:155], v200 offset:4096
    v_mfma_f32_16x16x32_bf16 v[28:31], v[180:183], v[188:191], v[28:31]
    ds_read_b128 v[156:159], v200 offset:6144
    v_mfma_f32_16x16x32_bf16 v[0:3], v[96:99], v[112:115], v[0:3]
    ds_read_b128 v[160:163], v202 offset:0
    v_mfma_f32_16x16x32_bf16 v[8:11], v[100:103], v[112:115], v[8:11]
    ds_read_b128 v[164:167], v202 offset:2048
    v_mfma_f32_16x16x32_bf16 v[16:19], v[104:107], v[112:115], v[16:19]
    ds_read_b128 v[168:171], v201 offset:0
    v_mfma_f32_16x16x32_bf16 v[24:27], v[108:111], v[112:115], v[24:27]
    ds_read_b128 v[172:175], v201 offset:2048
    v_mfma_f32_16x16x32_bf16 v[4:7], v[96:99], v[116:119], v[4:7]
    ds_read_b128 v[176:179], v201 offset:4096
    v_mfma_f32_16x16x32_bf16 v[12:15], v[100:103], v[116:119], v[12:15]
    ds_read_b128 v[180:183], v201 offset:6144
    v_mfma_f32_16x16x32_bf16 v[20:23], v[104:107], v[116:119], v[20:23]
    ds_read_b128 v[184:187], v203 offset:0
    v_mfma_f32_16x16x32_bf16 v[28:31], v[108:111], v[116:119], v[28:31]
    ds_read_b128 v[188:191], v203 offset:2048
    v_mfma_f32_16x16x32_bf16 v[0:3], v[120:123], v[136:139], v[0:3]
    v_mfma_f32_16x16x32_bf16 v[8:11], v[124:127], v[136:139], v[8:11]
    v_mfma_f32_16x16x32_bf16 v[16:19], v[128:131], v[136:139], v[16:19]
    v_mfma_f32_16x16x32_bf16 v[24:27], v[132:135], v[136:139], v[24:27]
    s_waitcnt lgkmcnt(0)
    v_mfma_f32_16x16x32_bf16 v[4:7], v[120:123], v[140:143], v[4:7]
    v_mfma_f32_16x16x32_bf16 v[12:15], v[124:127], v[140:143], v[12:15]
    v_mfma_f32_16x16x32_bf16 v[20:23], v[128:131], v[140:143], v[20:23]
    v_mfma_f32_16x16x32_bf16 v[28:31], v[132:135], v[140:143], v[28:31]
    v_mfma_f32_16x16x32_bf16 v[0:3], v[144:147], v[160:163], v[0:3]
    v_mfma_f32_16x16x32_bf16 v[8:11], v[148:151], v[160:163], v[8:11]
    v_mfma_f32_16x16x32_bf16 v[16:19], v[152:155], v[160:163], v[16:19]
    v_mfma_f32_16x16x32_bf16 v[24:27], v[156:159], v[160:163], v[24:27]
    v_mfma_f32_16x16x32_bf16 v[4:7], v[144:147], v[164:167], v[4:7]
    v_mfma_f32_16x16x32_bf16 v[12:15], v[148:151], v[164:167], v[12:15]
    v_mfma_f32_16x16x32_bf16 v[20:23], v[152:155], v[164:167], v[20:23]
    v_mfma_f32_16x16x32_bf16 v[28:31], v[156:159], v[164:167], v[28:31]
    v_mfma_f32_16x16x32_bf16 v[0:3], v[168:171], v[184:187], v[0:3]
    v_mfma_f32_16x16x32_bf16 v[8:11], v[172:175], v[184:187], v[8:11]
    v_mfma_f32_16x16x32_bf16 v[16:19], v[176:179], v[184:187], v[16:19]
    v_mfma_f32_16x16x32_bf16 v[24:27], v[180:183], v[184:187], v[24:27]
    v_mfma_f32_16x16x32_bf16 v[4:7], v[168:171], v[188:191], v[4:7]
    v_mfma_f32_16x16x32_bf16 v[12:15], v[172:175], v[188:191], v[12:15]
    v_mfma_f32_16x16x32_bf16 v[20:23], v[176:179], v[188:191], v[20:23]
    v_mfma_f32_16x16x32_bf16 v[28:31], v[180:183], v[188:191], v[28:31]
    s_nop 7
    v_cvt_pk_bf16_f32 v64, v0, v1
    v_cvt_pk_bf16_f32 v65, v2, v3
    v_cvt_pk_bf16_f32 v66, v8, v9
    v_cvt_pk_bf16_f32 v67, v10, v11
    v_cvt_pk_bf16_f32 v68, v4, v5
    v_cvt_pk_bf16_f32 v69, v6, v7
    v_cvt_pk_bf16_f32 v70, v12, v13
    v_cvt_pk_bf16_f32 v71, v14, v15
    v_cvt_pk_bf16_f32 v72, v16, v17
    v_cvt_pk_bf16_f32 v73, v18, v19
    v_cvt_pk_bf16_f32 v74, v24, v25
    v_cvt_pk_bf16_f32 v75, v26, v27
    v_cvt_pk_bf16_f32 v76, v20, v21
    v_cvt_pk_bf16_f32 v77, v22, v23
    v_cvt_pk_bf16_f32 v78, v28, v29
    v_cvt_pk_bf16_f32 v79, v30, v31
    s_nop 1
    v_permlane16_swap_b32 v64, v66
    v_permlane16_swap_b32 v65, v67
    v_permlane16_swap_b32 v68, v70
    v_permlane16_swap_b32 v69, v71
    v_permlane16_swap_b32 v72, v74
    v_permlane16_swap_b32 v73, v75
    v_permlane16_swap_b32 v76, v78
    v_permlane16_swap_b32 v77, v79
    v_mov_b32 v80, v64
    v_mov_b32 v81, v65
    v_mov_b32 v82, v66
    v_mov_b32 v83, v67
    v_mov_b32 v84, v68
    v_mov_b32 v85, v69
    v_mov_b32 v86, v70
    v_mov_b32 v87, v71
    s_nop 1
    v_mov_b32_dpp v64, v72 row_ror:8 row_mask:0xf bank_mask:0xc
    v_mov_b32_dpp v65, v73 row_ror:8 row_mask:0xf bank_mask:0xc
    v_mov_b32_dpp v66, v74 row_ror:8 row_mask:0xf bank_mask:0xc
    v_mov_b32_dpp v67, v75 row_ror:8 row_mask:0xf bank_mask:0xc
    v_mov_b32_dpp v68, v76 row_ror:8 row_mask:0xf bank_mask:0xc
    v_mov_b32_dpp v69, v77 row_ror:8 row_mask:0xf bank_mask:0xc
    v_mov_b32_dpp v70, v78 row_ror:8 row_mask:0xf bank_mask:0xc
    v_mov_b32_dpp v71, v79 row_ror:8 row_mask:0xf bank_mask:0xc
    v_mov_b32_dpp v72, v80 row_ror:8 row_mask:0xf bank_mask:0x3
    v_mov_b32_dpp v73, v81 row_ror:8 row_mask:0xf bank_mask:0x3
    v_mov_b32_dpp v74, v82 row_ror:8 row_mask:0xf bank_mask:0x3
    v_mov_b32_dpp v75, v83 row_ror:8 row_mask:0xf bank_mask:0x3
    v_mov_b32_dpp v76, v84 row_ror:8 row_mask:0xf bank_mask:0x3
    v_mov_b32_dpp v77, v85 row_ror:8 row_mask:0xf bank_mask:0x3
    v_mov_b32_dpp v78, v86 row_ror:8 row_mask:0xf bank_mask:0x3
    v_mov_b32_dpp v79, v87 row_ror:8 row_mask:0xf bank_mask:0x3
    buffer_store_dwordx4 v[64:67], v214, s[56:59], s44 offen
    buffer_store_dwordx4 v[68:71], v214, s[56:59], s45 offen
    buffer_store_dwordx4 v[72:75], v213, s[56:59], s44 offen
    buffer_store_dwordx4 v[76:79], v213, s[56:59], s45 offen
L_exit:
    s_endpgm
L_end:
.section .rodata,"a"
.p2align 6
.amdhsa_kernel standalone__spectral_fnet__prompt_kernel
  .amdhsa_next_free_vgpr 224
  .amdhsa_next_free_sgpr 100
  .amdhsa_accum_offset 224
  .amdhsa_group_segment_fixed_size 0
  .amdhsa_kernarg_size 64
  .amdhsa_user_sgpr_count 2
  .amdhsa_user_sgpr_kernarg_segment_ptr 1
  .amdhsa_system_sgpr_workgroup_id_x 1
.end_amdhsa_kernel
```
